```python
import torch

def _softmax(x, axis=-1):
    return torch.softmax(x, dim=axis)

def _gelu(x):
    return torch.nn.functional.gelu(x, approximate='tanh')

def _silu(x):
    return torch.nn.functional.silu(x)

def _sigmoid(x):
    return torch.sigmoid(x)

def _layernorm(x, axis=-1, eps=1e-05):
    m = x.mean(dim=axis, keepdim=True)
    v = x.var(dim=axis, keepdim=True, unbiased=False)
    return (x - m) / torch.sqrt(v + eps)

def _scatter_add(tgt, idx, src, axis=0):
    return tgt.clone().index_add_(axis, idx, src)

def _segment_sum(src, seg, n):
    out = torch.zeros((n,) + src.shape[1:], dtype=src.dtype)
    return out.index_add_(0, seg, src)

def _pad(x, pw):
    flat = tuple((v for pair in reversed(pw) for v in pair))
    return torch.nn.functional.pad(x, flat)
kernel_name = 'adaLN_cond__ssm_conv_s4d__swiglu_ffn__prompt'

def setup_inputs():

    _w = lambda a: (lambda t: t.to(torch.bfloat16) if t.is_floating_point() else t)(torch.as_tensor(a))

    def _A_setup():
        Bsz, L, D, N = (1, 2048, 512, 128)
        return {'u': _w((lambda *s: torch.randn(*s, dtype=torch.bfloat16) * 0.05)(Bsz, L, D)), 'log_A_real': _w((lambda *s: torch.randn(*s, dtype=torch.bfloat16) * 3.2)(D, N) * 0.5), 'A_imag': _w((lambda *s: torch.randn(*s, dtype=torch.bfloat16) * 0.1)(D, N) * 3.14), 'C_real': _w((lambda *s: torch.randn(*s, dtype=torch.bfloat16) * 0.4)(D, N) / N ** 0.5), 'C_imag': _w((lambda *s: torch.randn(*s, dtype=torch.bfloat16) * 0.4)(D, N) / N ** 0.5), 'log_dt': _w((lambda *s: torch.randn(*s, dtype=torch.bfloat16) * 0.1)(D) * 0.5 - 4.0), 'D_skip': _w((lambda *s: torch.randn(*s, dtype=torch.bfloat16) * 0.1)(D))}
    _A_in = _A_setup()

    def _B_setup():
        B, S, D, F = (1, 2048, 512, 1792)
        return {'x': _w((lambda *s: torch.randn(*s, dtype=torch.bfloat16) * 0.05)(B, S, D)), 'w_gate': _w((lambda *s: torch.randn(*s, dtype=torch.bfloat16) * 0.05)(D, F)), 'w_up': _w((lambda *s: torch.randn(*s, dtype=torch.bfloat16) * 0.05)(D, F)), 'w_down': _w((lambda *s: torch.randn(*s, dtype=torch.bfloat16) * 0.05)(F, D))}
    _B_in = _B_setup()
    return {'A_u': _A_in['u'], 'A_log_A_real': _A_in['log_A_real'], 'A_A_imag': _A_in['A_imag'], 'A_C_real': _A_in['C_real'], 'A_C_imag': _A_in['C_imag'], 'A_log_dt': _A_in['log_dt'], 'A_D_skip': _A_in['D_skip'], 'B_x': _B_in['x'], 'B_w_gate': _B_in['w_gate'], 'B_w_up': _B_in['w_up'], 'B_w_down': _B_in['w_down'], 'c': _w((lambda *s: torch.randn(*s, dtype=torch.bfloat16) * 0.2)(1, 512) * 8.0), 'w_mod': _w((lambda *s: torch.randn(*s, dtype=torch.bfloat16) * 0.2)(512, 6 * 512) * 512 ** (-0.5) * 8.0)}

def reference(A_u, A_log_A_real, A_A_imag, A_C_real, A_C_imag, A_log_dt, A_D_skip, B_x, B_w_gate, B_w_up, B_w_down, c, w_mod):

    def _A_ref(u, log_A_real, A_imag, C_real, C_imag, log_dt, D_skip):
        L = u.shape[1]
        dt = torch.exp(log_dt)
        A = -torch.exp(log_A_real) + 1j * A_imag
        C = (C_real + 1j * C_imag) * dt[:, None]
        pos = (lambda x, dt: x.to(dt))(torch.arange(L), log_dt.dtype)
        P = torch.exp((A * dt[:, None])[:, :, None] * pos[None, None, :])
        K = 2.0 * torch.einsum('dn,dnl->dl', C, P).real
        L2 = 2 * L
        u_t = (lambda x, *d: x.permute(*d))(u, 0, 2, 1)
        Kf = (lambda x, *a, **k: torch.fft.rfft(x.float(), *a, **k))(K, L2)
        Uf = (lambda x, *a, **k: torch.fft.rfft(x.float(), *a, **k))(u_t, L2)
        y = (lambda x, *a, **k: torch.fft.irfft(x, *a, **k).to(torch.bfloat16))(Uf * Kf[None, :, :], L2)[:, :, :L]
        y = (lambda x, *d: x.permute(*d))(y, 0, 2, 1)
        return y + u * D_skip[None, None, :]

    def _B_ref(x, w_gate, w_up, w_down):
        g = _silu(x @ w_gate)
        u = x @ w_up
        return g * u @ w_down
    x = A_u
    mod = (_silu(c) @ w_mod).reshape(c.shape[0], 6, 1, -1)
    sa, ca, ga, sb, cb, gb = (mod[:, 0].clone(), mod[:, 1].clone(), mod[:, 2].clone(), mod[:, 3].clone(), mod[:, 4].clone(), mod[:, 5].clone())
    h = _layernorm(x, axis=-1) * (1 + ca) + sa
    x = x + ga * _A_ref(h, A_log_A_real, A_A_imag, A_C_real, A_C_imag, A_log_dt, A_D_skip)
    h = _layernorm(x, axis=-1) * (1 + cb) + sb
    x = x + gb * _B_ref(h, B_w_gate, B_w_up, B_w_down)
    return x
```

```asm
; @launch grid=(256,1,1) block=(256,1,1) lds=163840
.amdgcn_target "amdgcn-amd-amdhsa--gfx950"
.text
.globl adaLN_cond__ssm_conv_s4d__swiglu_ffn__prompt_kernel
.p2align 8
.type adaLN_cond__ssm_conv_s4d__swiglu_ffn__prompt_kernel,@function
adaLN_cond__ssm_conv_s4d__swiglu_ffn__prompt_kernel:
    s_cmp_ge_u32 s2, 256
    s_cbranch_scc1 L_end
    s_load_dwordx16 s[16:31], s[0:1], 0
    s_load_dwordx16 s[32:47], s[0:1], 64
    s_getpc_b64 s[6:7]
L_pc:
    v_lshrrev_b32 v4, 6, v0
    s_lshr_b32 s4, s2, 3
    s_and_b32 s3, s2, 7
    v_readfirstlane_b32 s5, v4
    s_lshl_b32 s8, s4, 11
    v_lshl_add_u32 v5, v0, 3, s8
    v_min_u32 v5, L_code_end-L_pc-4, v5
    global_load_dword v5, v5, s[6:7]
    v_and_b32 v1, 63, v0
    v_and_b32 v2, 15, v0
    v_bfe_u32 v3, v0, 4, 2
    s_lshr_b32 s8, s4, 1
    s_lshl_b32 s9, s3, 4
    s_add_u32 s8, s8, s9
    s_and_b32 s9, s4, 1
    s_lshl_b32 s10, s8, 14
    s_lshl_b32 s11, s9, 13
    s_lshl_b32 s12, s5, 11
    s_add_u32 s11, s11, s12
    s_add_u32 s80, s10, s11
    s_lshr_b32 s12, s11, 4
    s_add_u32 s81, s10, s12
    s_mul_i32 s8, s8, 16512
    s_add_u32 s82, s8, s11
    s_mul_i32 s8, s3, 6
    s_lshr_b32 s9, s4, 2
    s_add_u32 s8, s8, s9
    s_and_b32 s9, s4, 3
    s_lshl_b32 s9, s9, 2
    s_add_u32 s9, s9, s5
    s_mul_i32 s10, s9, 196608
    s_lshl_b32 s11, s8, 7
    s_add_u32 s10, s10, s11
    s_lshr_b32 s11, s9, 2
    s_mul_i32 s11, s11, 12288
    s_lshl_b32 s8, s8, 8
    s_add_u32 s8, s8, s11
    s_add_u32 s8, s8, 19333120
    s_cmp_lt_u32 s4, 24
    s_cselect_b32 s83, s10, 1073741824
    s_cselect_b32 s93, s8, 1073741824
    s_cmp_eq_u32 s5, 0
    s_cselect_b32 s93, s93, 1073741824
    s_add_u32 s84, s83, 6144
    s_add_u32 s85, s83, 12288
    s_add_u32 s86, s83, 18432
    s_lshl_b32 s13, s9, 6
    s_lshl_b32 s8, s3, 5
    s_add_u32 s76, s8, s4
    v_lshlrev_b32 v6, 4, v1
    v_lshlrev_b32 v7, 12, v3
    v_lshl_add_u32 v7, v2, 3, v7
    v_lshrrev_b32 v9, 3, v1
    v_mul_u32_u24 v8, 24576, v9
    v_and_b32 v4, 7, v0
    v_lshl_add_u32 v8, v4, 4, v8
    v_lshl_add_u32 v9, v9, 3, s13
    s_lshl_b32 s8, s76, 9
    v_lshl_add_u32 v10, v0, 1, s8
    s_lshl_b32 s9, s76, 2
    v_lshrrev_b32 v4, 7, v0
    v_lshl_add_u32 v11, v4, 1, s9
    v_mov_b32 v12, s9
    s_mul_i32 s8, s2, 768
    s_add_u32 s8, s8, 19070976
    v_lshl_add_u32 v19, v1, 4, s8
    s_bfm_b64 s[12:13], 48, 0
    s_cmp_eq_u32 s5, 0
    s_cselect_b64 s[12:13], s[12:13], 0
    v_mov_b32 v18, 18939904
    v_mov_b32 v14, 0
    v_mov_b32 v15, 0
    v_mov_b32 v16, 0
    v_mov_b32 v17, 0
    s_and_b32 s8, s3, 1
    s_waitcnt lgkmcnt(0)
    global_load_ushort v54, v10, s[18:19] nt
    global_load_ushort v55, v10, s[20:21] nt
    global_load_ushort v56, v10, s[22:23] nt
    global_load_ushort v57, v10, s[24:25] nt
    global_load_ushort v58, v11, s[26:27]
    s_mov_b32 s72, s16
    s_mov_b32 s73, s17
    s_mov_b32 s74, 2097152
    s_mov_b32 s75, 0x20000
    buffer_load_dwordx2 v[22:23], v7, s[72:75], s81 offen offset:0 nt
    buffer_load_dwordx2 v[24:25], v7, s[72:75], s81 offen offset:1024 nt
    buffer_load_dwordx2 v[26:27], v7, s[72:75], s81 offen offset:2048 nt
    buffer_load_dwordx2 v[28:29], v7, s[72:75], s81 offen offset:3072 nt
    buffer_load_dwordx4 v[30:33], v6, s[72:75], s80 offen offset:0 nt
    buffer_load_dwordx4 v[34:37], v6, s[72:75], s80 offen offset:1024 nt
    global_load_dwordx2 v[20:21], v9, s[38:39]
    s_mov_b32 s64, s40
    s_mov_b32 s65, s41
    s_mov_b32 s66, 3145728
    s_mov_b32 s67, 0x20000
    buffer_load_dwordx4 v[38:41], v8, s[64:67], s83 offen nt
    buffer_load_dwordx4 v[42:45], v8, s[64:67], s84 offen nt
    buffer_load_dwordx4 v[46:49], v8, s[64:67], s85 offen nt
    buffer_load_dwordx4 v[50:53], v8, s[64:67], s86 offen nt
    global_load_dword v59, v12, s[28:29]
    global_load_dword v18, v18, s[46:47] sc1
    s_mov_b64 exec, s[12:13]
    global_store_dwordx4 v19, v[14:17], s[46:47] sc1
    s_mov_b64 exec, -1
    s_mov_b32 s48, s46
    s_mov_b32 s49, s47
    s_mov_b32 s50, 268435456
    s_mov_b32 s51, 0x20000
    s_mov_b32 s52, s32
    s_mov_b32 s53, s33
    s_mov_b32 s54, 1835008
    s_mov_b32 s55, 0x20000
    s_mov_b32 s56, s34
    s_mov_b32 s57, s35
    s_mov_b32 s58, 1835008
    s_mov_b32 s59, 0x20000
    s_mov_b32 s60, s42
    s_mov_b32 s61, s43
    s_mov_b32 s62, 2097152
    s_mov_b32 s63, 0x20000
    s_mov_b32 s68, s36
    s_mov_b32 s69, s37
    s_mov_b32 s70, 1835008
    s_mov_b32 s71, 0x20000
    s_lshl_b32 s8, s8, 2
    s_and_b32 s9, s4, 3
    s_add_u32 s77, s8, s9
    s_lshr_b32 s8, s3, 1
    s_lshr_b32 s9, s4, 2
    s_lshl_b32 s10, s8, 3
    s_add_u32 s78, s10, s9
    s_lshl_b32 s79, s5, 10
    s_lshl_b32 s8, s8, 7
    s_lshl_b32 s9, s9, 2
    s_add_u32 s8, s8, s9
    s_lshl_b32 s9, s77, 11
    s_add_u32 s8, s8, s9
    s_add_u32 s87, s8, 19079168
    s_lshl_b32 s8, s3, 10
    s_lshl_b32 s9, s4, 5
    s_add_u32 s8, s8, s9
    s_add_u32 s88, s8, 19070976
    s_lshl_b32 s8, s4, 7
    s_lshl_b32 s9, s3, 2
    s_add_u32 s89, s8, s9
    v_lshl_add_u32 v60, v1, 12, s89
    v_lshrrev_b32 v4, 1, v1
    v_lshlrev_b32 v13, 7, v4
    v_and_b32 v4, 1, v0
    v_lshl_add_u32 v13, v4, 4, v13
    s_lshl_b32 s8, s3, 12
    s_add_u32 s8, s8, 19005440
    v_add_u32 v13, s8, v13
    s_lshr_b32 s8, s2, 4
    s_lshl_b32 s8, s8, 7
    s_and_b32 s9, s2, 15
    s_lshl_b32 s9, s9, 2
    s_add_u32 s8, s8, s9
    v_lshl_add_u32 v61, v0, 11, s8
    v_lshrrev_b32 v4, 4, v0
    v_lshlrev_b32 v4, 7, v4
    v_lshl_add_u32 v4, v2, 2, v4
    s_and_b32 s8, s2, 63
    s_lshl_b32 s8, s8, 11
    v_add_u32 v62, s8, v4
    s_movk_i32 s8, 3472
    v_add_u32 v4, 0, v0
    v_mul_u32_u24 v63, 9363, v4
    v_lshlrev_b32 v4, 4, v4
    v_lshrrev_b32 v63, 16, v63
    v_mad_u32_u24 v64, v63, s8, v4
    v_add_u32 v4, 256, v0
    v_mul_u32_u24 v63, 9363, v4
    v_lshlrev_b32 v4, 4, v4
    v_lshrrev_b32 v63, 16, v63
    v_mad_u32_u24 v65, v63, s8, v4
    v_add_u32 v4, 512, v0
    v_mul_u32_u24 v63, 9363, v4
    v_lshlrev_b32 v4, 4, v4
    v_lshrrev_b32 v63, 16, v63
    v_mad_u32_u24 v66, v63, s8, v4
    v_add_u32 v4, 768, v0
    v_mul_u32_u24 v63, 9363, v4
    v_lshlrev_b32 v4, 4, v4
    v_lshrrev_b32 v63, 16, v63
    v_mad_u32_u24 v67, v63, s8, v4
    v_add_u32 v4, 1024, v0
    v_mul_u32_u24 v63, 9363, v4
    v_lshlrev_b32 v4, 4, v4
    v_lshrrev_b32 v63, 16, v63
    v_mad_u32_u24 v68, v63, s8, v4
    v_add_u32 v4, 1280, v0
    v_mul_u32_u24 v63, 9363, v4
    v_lshlrev_b32 v4, 4, v4
    v_lshrrev_b32 v63, 16, v63
    v_mad_u32_u24 v69, v63, s8, v4
    v_add_u32 v4, 1536, v0
    v_mul_u32_u24 v63, 9363, v4
    v_lshlrev_b32 v4, 4, v4
    v_lshrrev_b32 v63, 16, v63
    v_mad_u32_u24 v70, v63, s8, v4
    s_mul_i32 s8, s78, 112
    s_add_u32 s9, s8, 917504
    s_add_u32 s10, s79, 28672
    s_cmp_lt_u32 s77, 4
    s_cselect_b32 s90, s8, s9
    s_cselect_b32 s91, s9, s8
    s_cselect_b32 s14, s79, s10
    s_cselect_b32 s15, s10, s79
    v_lshrrev_b32 v71, 7, v0
    v_and_b32 v90, 127, v0
    v_mul_u32_u24 v91, 1536, v71
    v_add_u32 v91, 60160, v91
    v_lshlrev_b32 v4, 3, v90
    v_sub_u32 v4, 2048, v4
    v_cvt_f32_u32 v92, v4
    v_add_f32 v93, 0xbf800000, v92
    v_add_f32 v94, 0xc0000000, v92
    v_add_f32 v95, 0xc0400000, v92
    v_add_f32 v96, 0xc0800000, v92
    v_add_f32 v97, 0xc0a00000, v92
    v_add_f32 v98, 0xc0c00000, v92
    v_add_f32 v99, 0xc0e00000, v92
    v_add_f32 v100, 0xc1000000, v92
    v_cvt_pk_bf16_f32 v92, v92, v93
    v_cvt_pk_bf16_f32 v94, v94, v95
    v_cvt_pk_bf16_f32 v96, v96, v97
    v_cvt_pk_bf16_f32 v98, v98, v99
    v_cvt_pk_bf16_f32 v100, v100, v100
    v_mad_u32_u16 v72, v92, 2, v91
    v_mad_u32_u16 v73, v92, 2, v91 op_sel:[1,0,0,0]
    v_mad_u32_u16 v74, v94, 2, v91
    v_mad_u32_u16 v75, v94, 2, v91 op_sel:[1,0,0,0]
    v_mad_u32_u16 v76, v96, 2, v91
    v_mad_u32_u16 v77, v96, 2, v91 op_sel:[1,0,0,0]
    v_mad_u32_u16 v78, v98, 2, v91
    v_mad_u32_u16 v79, v98, 2, v91 op_sel:[1,0,0,0]
    v_mad_u32_u16 v80, v100, 2, v91
    v_lshlrev_b32 v4, 3, v90
    v_sub_u32 v4, 1024, v4
    v_cmp_le_u32 vcc, 112, v90
    v_mov_b32 v63, 0x80
    s_nop 0
    v_cndmask_b32 v63, 0, v63, vcc
    v_add_u32 v4, v4, v63
    v_lshlrev_b32 v63, 1, v63
    v_sub_u32 v91, v91, v63
    v_cvt_f32_u32 v92, v4
    v_add_f32 v93, 0xbf800000, v92
    v_add_f32 v94, 0xc0000000, v92
    v_add_f32 v95, 0xc0400000, v92
    v_add_f32 v96, 0xc0800000, v92
    v_add_f32 v97, 0xc0a00000, v92
    v_add_f32 v98, 0xc0c00000, v92
    v_add_f32 v99, 0xc0e00000, v92
    v_add_f32 v100, 0xc1000000, v92
    v_cvt_pk_bf16_f32 v92, v92, v93
    v_cvt_pk_bf16_f32 v94, v94, v95
    v_cvt_pk_bf16_f32 v96, v96, v97
    v_cvt_pk_bf16_f32 v98, v98, v99
    v_cvt_pk_bf16_f32 v100, v100, v100
    v_mad_u32_u16 v81, v92, 2, v91
    v_mad_u32_u16 v82, v92, 2, v91 op_sel:[1,0,0,0]
    v_mad_u32_u16 v83, v94, 2, v91
    v_mad_u32_u16 v84, v94, 2, v91 op_sel:[1,0,0,0]
    v_mad_u32_u16 v85, v96, 2, v91
    v_mad_u32_u16 v86, v96, 2, v91 op_sel:[1,0,0,0]
    v_mad_u32_u16 v87, v98, 2, v91
    v_mad_u32_u16 v88, v98, 2, v91 op_sel:[1,0,0,0]
    v_mad_u32_u16 v89, v100, 2, v91
    v_mul_u32_u24 v91, 8320, v71
    v_lshl_add_u32 v91, v90, 4, v91
    v_add_u32 v91, 114688, v91
    v_mul_u32_u24 v98, 4608, v71
    v_lshl_add_u32 v98, v90, 2, v98
    v_add_u32 v98, 131328, v98
    s_mul_i32 s8, s5, 15504
    s_add_u32 s92, s8, 101824
    v_lshl_add_u32 v92, v1, 2, s92
    v_mul_u32_u24 v4, 272, v2
    v_lshl_add_u32 v4, v3, 4, v4
    v_add_u32 v93, s92, v4
    v_mul_u32_u24 v71, 1536, v71
    v_add_u32 v71, 94208, v71
    v_cmp_le_u32 vcc, 2, v3
    v_lshl_add_u32 v4, v3, 3, v71
    v_lshl_add_u32 v4, v2, 4, v4
    v_add_u32 v63, 240, v4
    v_cndmask_b32 v94, v4, v63, vcc
    v_lshl_add_u32 v71, v3, 7, v71
    v_lshlrev_b32 v4, 3, v2
    v_lshlrev_b32 v63, 2, v2
    v_cndmask_b32 v4, v4, v63, vcc
    v_add_u32 v95, v4, v71
    v_mov_b32 v63, 64
    v_cndmask_b32 v4, 4, v63, vcc
    v_add_u32 v96, v4, v95
    v_lshl_add_u32 v97, v2, 1, v71
    s_waitcnt vmcnt(18)
    v_lshlrev_b32 v54, 16, v54
    s_waitcnt vmcnt(17)
    v_lshlrev_b32 v55, 16, v55
    s_waitcnt vmcnt(16)
    v_lshlrev_b32 v56, 16, v56
    s_waitcnt vmcnt(15)
    v_lshlrev_b32 v57, 16, v57
    s_waitcnt vmcnt(14)
    v_lshlrev_b32 v58, 16, v58
    v_mul_f32 v54, 0x3fb8aa3b, v54
    v_mul_f32 v58, 0x3fb8aa3b, v58
    v_exp_f32 v54, v54
    v_exp_f32 v58, v58
    v_max_f32 v8, abs(v56), abs(v57)
    v_cvt_pk_bf16_f32 v54, v54, v58
    s_nop 0
    v_max_f32_dpp v8, v8, v8 row_ror:8 row_mask:0xf bank_mask:0xf
    v_and_b32 v58, 0xffff0000, v54
    v_lshlrev_b32 v54, 16, v54
    v_max_f32_dpp v8, v8, v8 row_ror:4 row_mask:0xf bank_mask:0xf
    v_mul_f32 v54, v54, v58
    v_mul_f32 v55, v55, v58
    v_max_f32_dpp v8, v8, v8 row_ror:2 row_mask:0xf bank_mask:0xf
    v_mul_f32 v54, 0xbfb8aa3b, v54
    v_mul_f32 v55, 0.15915494, v55
    v_max_f32_dpp v8, v8, v8 row_ror:1 row_mask:0xf bank_mask:0xf
    v_fract_f32 v10, v55
    v_exp_f32 v9, v54
    v_cos_f32 v16, v10
    v_sin_f32 v17, v10
    v_readlane_b32 s8, v8, 0
    v_readlane_b32 s9, v8, 16
    v_readlane_b32 s10, v8, 32
    v_readlane_b32 s11, v8, 48
    v_pk_mul_f32 v[16:17], v[16:17], v[8:9] op_sel:[0,1] op_sel_hi:[1,1]
    v_mul_f32 v9, 0x41000000, v54
    v_mul_f32 v10, 0x41000000, v55
    v_fract_f32 v10, v10
    v_exp_f32 v9, v9
    v_cos_f32 v112, v10
    v_sin_f32 v113, v10
    s_nop 0
    v_pk_mul_f32 v[112:113], v[112:113], v[8:9] op_sel:[0,1] op_sel_hi:[1,1]
    v_mul_f32 v9, 0x43000000, v54
    v_mul_f32 v10, 0x43000000, v55
    v_fract_f32 v10, v10
    v_exp_f32 v9, v9
    v_cos_f32 v114, v10
    v_sin_f32 v115, v10
    s_nop 0
    v_pk_mul_f32 v[114:115], v[114:115], v[8:9] op_sel:[0,1] op_sel_hi:[1,1]
    s_max_u32 s8, s8, s9
    s_max_u32 s10, s10, s11
    s_max_u32 s8, s8, s10
    s_and_b32 s8, s8, 0x7f800000
    s_sub_u32 s9, 0x7f000000, s8
    v_mul_f32 v130, s9, v56
    v_mul_f32 v131, s9, v57
    v_mul_f32 v58, s8, v58
    v_add_f32 v58, v58, v58
    v_mov_b32 v145, 0x3c00
    ds_write_b32 v92, v145
    v_cvt_pk_f16_f32 v142, v16, v17
    ds_write_b32 v92, v142 offset:272
    v_cvt_pk_f16_f32 v143, v114, v115
    ds_write_b32 v92, v143 offset:2176
    v_cvt_pk_f16_f32 v144, v130, -v131
    ds_write_b32 v92, v144 offset:11152
    v_pk_mul_f32 v[134:135], v[130:131], v[112:113] op_sel:[0,0] op_sel_hi:[0,1]
    s_lshl_b32 s8, s4, 4
    s_lshl_b32 s9, s5, 2
    s_add_u32 s8, s8, s9
    s_mul_i32 s8, s8, 3584
    s_lshr_b32 s9, s3, 1
    s_mul_i32 s9, s9, 896
    s_add_u32 s8, s8, s9
    v_min_u32 v4, 13, v2
    v_mul_u32_u24 v147, 3584, v3
    v_lshl_add_u32 v4, v4, 6, v147
    buffer_load_dword v146, v4, s[52:55], s8 offen
    buffer_load_dword v147, v4, s[56:59], s8 offen
    v_pk_mul_f32 v[100:101], v[16:17], v[16:17] op_sel:[0,0] op_sel_hi:[0,1]
    v_pk_fma_f32 v[132:133], v[130:131], v[112:113], v[134:135] op_sel:[1,1,0] op_sel_hi:[1,0,1] neg_lo:[1,0,0]
    v_pk_mul_f32 v[138:139], v[132:133], v[112:113] op_sel:[0,0] op_sel_hi:[0,1]
    v_pk_fma_f32 v[100:101], v[16:17], v[16:17], v[100:101] op_sel:[1,1,0] op_sel_hi:[1,0,1] neg_lo:[1,0,0]
    v_cvt_pk_f16_f32 v144, v132, -v133
    ds_write_b32 v92, v144 offset:11424
    v_pk_mul_f32 v[102:103], v[100:101], v[16:17] op_sel:[0,0] op_sel_hi:[0,1]
    v_pk_fma_f32 v[130:131], v[132:133], v[112:113], v[138:139] op_sel:[1,1,0] op_sel_hi:[1,0,1] neg_lo:[1,0,0]
    v_cvt_pk_f16_f32 v145, v100, v101
    ds_write_b32 v92, v145 offset:544
    v_pk_mul_f32 v[134:135], v[130:131], v[112:113] op_sel:[0,0] op_sel_hi:[0,1]
    v_pk_fma_f32 v[102:103], v[100:101], v[16:17], v[102:103] op_sel:[1,1,0] op_sel_hi:[1,0,1] neg_lo:[1,0,0]
    v_cvt_pk_f16_f32 v142, v130, -v131
    ds_write_b32 v92, v142 offset:11696
    v_pk_mul_f32 v[104:105], v[100:101], v[100:101] op_sel:[0,0] op_sel_hi:[0,1]
    v_pk_fma_f32 v[132:133], v[130:131], v[112:113], v[134:135] op_sel:[1,1,0] op_sel_hi:[1,0,1] neg_lo:[1,0,0]
    v_cvt_pk_f16_f32 v143, v102, v103
    ds_write_b32 v92, v143 offset:816
    v_pk_mul_f32 v[138:139], v[132:133], v[112:113] op_sel:[0,0] op_sel_hi:[0,1]
    v_pk_fma_f32 v[104:105], v[100:101], v[100:101], v[104:105] op_sel:[1,1,0] op_sel_hi:[1,0,1] neg_lo:[1,0,0]
    v_cvt_pk_f16_f32 v144, v132, -v133
    ds_write_b32 v92, v144 offset:11968
    v_pk_mul_f32 v[116:117], v[114:115], v[114:115] op_sel:[0,0] op_sel_hi:[0,1]
    v_pk_fma_f32 v[130:131], v[132:133], v[112:113], v[138:139] op_sel:[1,1,0] op_sel_hi:[1,0,1] neg_lo:[1,0,0]
    v_cvt_pk_f16_f32 v145, v104, v105
    ds_write_b32 v92, v145 offset:1088
    v_pk_mul_f32 v[134:135], v[130:131], v[112:113] op_sel:[0,0] op_sel_hi:[0,1]
    v_pk_fma_f32 v[116:117], v[114:115], v[114:115], v[116:117] op_sel:[1,1,0] op_sel_hi:[1,0,1] neg_lo:[1,0,0]
    v_cvt_pk_f16_f32 v142, v130, -v131
    ds_write_b32 v92, v142 offset:12240
    v_pk_mul_f32 v[106:107], v[104:105], v[16:17] op_sel:[0,0] op_sel_hi:[0,1]
    v_pk_fma_f32 v[132:133], v[130:131], v[112:113], v[134:135] op_sel:[1,1,0] op_sel_hi:[1,0,1] neg_lo:[1,0,0]
    v_cvt_pk_f16_f32 v143, v116, v117
    ds_write_b32 v92, v143 offset:4352
    v_pk_mul_f32 v[138:139], v[132:133], v[112:113] op_sel:[0,0] op_sel_hi:[0,1]
    v_pk_fma_f32 v[106:107], v[104:105], v[16:17], v[106:107] op_sel:[1,1,0] op_sel_hi:[1,0,1] neg_lo:[1,0,0]
    v_cvt_pk_f16_f32 v144, v132, -v133
    ds_write_b32 v92, v144 offset:12512
    s_waitcnt vmcnt(9)
    v_lshlrev_b32 v152, 16, v20
    v_and_b32 v153, 0xffff0000, v20
    v_lshlrev_b32 v154, 16, v21
    v_and_b32 v155, 0xffff0000, v21
    v_mul_f32 v156, 0xbfb8aa3b, v152
    v_mul_f32 v157, 0xbfb8aa3b, v153
    v_mul_f32 v158, 0xbfb8aa3b, v154
    v_mul_f32 v159, 0xbfb8aa3b, v155
    v_exp_f32 v156, v156
    v_exp_f32 v157, v157
    v_exp_f32 v158, v158
    v_exp_f32 v159, v159
    v_add_f32 v156, 1.0, v156
    v_add_f32 v157, 1.0, v157
    v_add_f32 v158, 1.0, v158
    v_add_f32 v159, 1.0, v159
    v_rcp_f32 v156, v156
    v_rcp_f32 v157, v157
    v_rcp_f32 v158, v158
    v_rcp_f32 v159, v159
    v_mul_f32 v156, v152, v156
    v_mul_f32 v157, v153, v157
    v_mul_f32 v158, v154, v158
    v_mul_f32 v159, v155, v159
    v_cvt_pk_bf16_f32 v148, v156, 0
    v_cvt_pk_bf16_f32 v149, v157, 0
    v_cvt_pk_bf16_f32 v150, v158, 0
    v_cvt_pk_bf16_f32 v151, v159, 0
    v_lshlrev_b32 v152, 16, v148
    v_lshlrev_b32 v153, 16, v149
    v_lshlrev_b32 v154, 16, v150
    v_lshlrev_b32 v155, 16, v151
    v_pk_mul_f32 v[108:109], v[104:105], v[100:101] op_sel:[0,0] op_sel_hi:[0,1]
    v_pk_fma_f32 v[130:131], v[132:133], v[112:113], v[138:139] op_sel:[1,1,0] op_sel_hi:[1,0,1] neg_lo:[1,0,0]
    v_cvt_pk_f16_f32 v145, v106, v107
    ds_write_b32 v92, v145 offset:1360
    v_pk_mul_f32 v[134:135], v[130:131], v[112:113] op_sel:[0,0] op_sel_hi:[0,1]
    v_pk_fma_f32 v[108:109], v[104:105], v[100:101], v[108:109] op_sel:[1,1,0] op_sel_hi:[1,0,1] neg_lo:[1,0,0]
    v_cvt_pk_f16_f32 v142, v130, -v131
    ds_write_b32 v92, v142 offset:12784
    v_pk_mul_f32 v[110:111], v[104:105], v[102:103] op_sel:[0,0] op_sel_hi:[0,1]
    v_pk_fma_f32 v[132:133], v[130:131], v[112:113], v[134:135] op_sel:[1,1,0] op_sel_hi:[1,0,1] neg_lo:[1,0,0]
    v_cvt_pk_f16_f32 v143, v108, v109
    ds_write_b32 v92, v143 offset:1632
    v_pk_mul_f32 v[138:139], v[132:133], v[112:113] op_sel:[0,0] op_sel_hi:[0,1]
    v_pk_fma_f32 v[110:111], v[104:105], v[102:103], v[110:111] op_sel:[1,1,0] op_sel_hi:[1,0,1] neg_lo:[1,0,0]
    v_cvt_pk_f16_f32 v144, v132, -v133
    ds_write_b32 v92, v144 offset:13056
    v_pk_mul_f32 v[118:119], v[116:117], v[114:115] op_sel:[0,0] op_sel_hi:[0,1]
    v_pk_fma_f32 v[130:131], v[132:133], v[112:113], v[138:139] op_sel:[1,1,0] op_sel_hi:[1,0,1] neg_lo:[1,0,0]
    v_cvt_pk_f16_f32 v145, v110, v111
    ds_write_b32 v92, v145 offset:1904
    v_pk_mul_f32 v[134:135], v[130:131], v[112:113] op_sel:[0,0] op_sel_hi:[0,1]
    v_pk_fma_f32 v[118:119], v[116:117], v[114:115], v[118:119] op_sel:[1,1,0] op_sel_hi:[1,0,1] neg_lo:[1,0,0]
    v_cvt_pk_f16_f32 v142, v130, -v131
    ds_write_b32 v92, v142 offset:13328
    v_pk_mul_f32 v[120:121], v[116:117], v[116:117] op_sel:[0,0] op_sel_hi:[0,1]
    v_pk_fma_f32 v[132:133], v[130:131], v[112:113], v[134:135] op_sel:[1,1,0] op_sel_hi:[1,0,1] neg_lo:[1,0,0]
    v_cvt_pk_f16_f32 v143, v118, v119
    ds_write_b32 v92, v143 offset:5440
    v_pk_mul_f32 v[138:139], v[132:133], v[112:113] op_sel:[0,0] op_sel_hi:[0,1]
    v_pk_fma_f32 v[120:121], v[116:117], v[116:117], v[120:121] op_sel:[1,1,0] op_sel_hi:[1,0,1] neg_lo:[1,0,0]
    v_cvt_pk_f16_f32 v144, v132, -v133
    ds_write_b32 v92, v144 offset:13600
    v_pk_mul_f32 v[122:123], v[120:121], v[114:115] op_sel:[0,0] op_sel_hi:[0,1]
    v_pk_fma_f32 v[130:131], v[132:133], v[112:113], v[138:139] op_sel:[1,1,0] op_sel_hi:[1,0,1] neg_lo:[1,0,0]
    v_cvt_pk_f16_f32 v145, v120, v121
    ds_write_b32 v92, v145 offset:6528
    v_pk_mul_f32 v[134:135], v[130:131], v[112:113] op_sel:[0,0] op_sel_hi:[0,1]
    v_pk_fma_f32 v[122:123], v[120:121], v[114:115], v[122:123] op_sel:[1,1,0] op_sel_hi:[1,0,1] neg_lo:[1,0,0]
    v_cvt_pk_f16_f32 v142, v130, -v131
    ds_write_b32 v92, v142 offset:13872
    v_pk_mul_f32 v[124:125], v[120:121], v[116:117] op_sel:[0,0] op_sel_hi:[0,1]
    v_pk_fma_f32 v[132:133], v[130:131], v[112:113], v[134:135] op_sel:[1,1,0] op_sel_hi:[1,0,1] neg_lo:[1,0,0]
    v_cvt_pk_f16_f32 v143, v122, v123
    ds_write_b32 v92, v143 offset:7072
    v_pk_mul_f32 v[138:139], v[132:133], v[112:113] op_sel:[0,0] op_sel_hi:[0,1]
    v_pk_fma_f32 v[124:125], v[120:121], v[116:117], v[124:125] op_sel:[1,1,0] op_sel_hi:[1,0,1] neg_lo:[1,0,0]
    v_cvt_pk_f16_f32 v144, v132, -v133
    ds_write_b32 v92, v144 offset:14144
    v_pk_mul_f32 v[126:127], v[120:121], v[118:119] op_sel:[0,0] op_sel_hi:[0,1]
    v_pk_fma_f32 v[130:131], v[132:133], v[112:113], v[138:139] op_sel:[1,1,0] op_sel_hi:[1,0,1] neg_lo:[1,0,0]
    v_cvt_pk_f16_f32 v145, v124, v125
    ds_write_b32 v92, v145 offset:7616
    v_pk_mul_f32 v[134:135], v[130:131], v[112:113] op_sel:[0,0] op_sel_hi:[0,1]
    v_pk_fma_f32 v[126:127], v[120:121], v[118:119], v[126:127] op_sel:[1,1,0] op_sel_hi:[1,0,1] neg_lo:[1,0,0]
    v_cvt_pk_f16_f32 v142, v130, -v131
    ds_write_b32 v92, v142 offset:14416
    v_pk_mul_f32 v[128:129], v[120:121], v[120:121] op_sel:[0,0] op_sel_hi:[0,1]
    v_pk_fma_f32 v[132:133], v[130:131], v[112:113], v[134:135] op_sel:[1,1,0] op_sel_hi:[1,0,1] neg_lo:[1,0,0]
    v_cvt_pk_f16_f32 v143, v126, v127
    ds_write_b32 v92, v143 offset:8160
    v_pk_mul_f32 v[138:139], v[132:133], v[112:113] op_sel:[0,0] op_sel_hi:[0,1]
    v_pk_fma_f32 v[128:129], v[120:121], v[120:121], v[128:129] op_sel:[1,1,0] op_sel_hi:[1,0,1] neg_lo:[1,0,0]
    v_cvt_pk_f16_f32 v144, v132, -v133
    ds_write_b32 v92, v144 offset:14688
    v_pk_mul_f32 v[140:141], v[114:115], v[16:17] op_sel:[0,0] op_sel_hi:[0,1]
    v_pk_fma_f32 v[130:131], v[132:133], v[112:113], v[138:139] op_sel:[1,1,0] op_sel_hi:[1,0,1] neg_lo:[1,0,0]
    v_cvt_pk_f16_f32 v145, v128, v129
    ds_write_b32 v92, v145 offset:8704
    v_pk_mul_f32 v[134:135], v[130:131], v[112:113] op_sel:[0,0] op_sel_hi:[0,1]
    v_pk_fma_f32 v[140:141], v[114:115], v[16:17], v[140:141] op_sel:[1,1,0] op_sel_hi:[1,0,1] neg_lo:[1,0,0]
    v_cvt_pk_f16_f32 v142, v130, -v131
    ds_write_b32 v92, v142 offset:14960
    v_pk_mul_f32 v[136:137], v[114:115], v[100:101] op_sel:[0,0] op_sel_hi:[0,1]
    v_pk_fma_f32 v[132:133], v[130:131], v[112:113], v[134:135] op_sel:[1,1,0] op_sel_hi:[1,0,1] neg_lo:[1,0,0]
    v_cvt_pk_f16_f32 v143, v140, v141
    ds_write_b32 v92, v143 offset:2448
    v_pk_mul_f32 v[138:139], v[114:115], v[102:103] op_sel:[0,0] op_sel_hi:[0,1]
    v_pk_fma_f32 v[136:137], v[114:115], v[100:101], v[136:137] op_sel:[1,1,0] op_sel_hi:[1,0,1] neg_lo:[1,0,0]
    v_cvt_pk_f16_f32 v144, v132, -v133
    ds_write_b32 v92, v144 offset:15232
    v_pk_mul_f32 v[140:141], v[114:115], v[104:105] op_sel:[0,0] op_sel_hi:[0,1]
    v_pk_fma_f32 v[138:139], v[114:115], v[102:103], v[138:139] op_sel:[1,1,0] op_sel_hi:[1,0,1] neg_lo:[1,0,0]
    v_cvt_pk_f16_f32 v145, v136, v137
    ds_write_b32 v92, v145 offset:2720
    v_pk_mul_f32 v[134:135], v[114:115], v[106:107] op_sel:[0,0] op_sel_hi:[0,1]
    v_pk_fma_f32 v[140:141], v[114:115], v[104:105], v[140:141] op_sel:[1,1,0] op_sel_hi:[1,0,1] neg_lo:[1,0,0]
    v_cvt_pk_f16_f32 v142, v138, v139
    ds_write_b32 v92, v142 offset:2992
    v_pk_mul_f32 v[136:137], v[114:115], v[108:109] op_sel:[0,0] op_sel_hi:[0,1]
    v_pk_fma_f32 v[134:135], v[114:115], v[106:107], v[134:135] op_sel:[1,1,0] op_sel_hi:[1,0,1] neg_lo:[1,0,0]
    v_cvt_pk_f16_f32 v143, v140, v141
    ds_write_b32 v92, v143 offset:3264
    v_pk_mul_f32 v[138:139], v[114:115], v[110:111] op_sel:[0,0] op_sel_hi:[0,1]
    v_pk_fma_f32 v[136:137], v[114:115], v[108:109], v[136:137] op_sel:[1,1,0] op_sel_hi:[1,0,1] neg_lo:[1,0,0]
    v_cvt_pk_f16_f32 v144, v134, v135
    ds_write_b32 v92, v144 offset:3536
    v_pk_mul_f32 v[140:141], v[116:117], v[100:101] op_sel:[0,0] op_sel_hi:[0,1]
    v_pk_fma_f32 v[138:139], v[114:115], v[110:111], v[138:139] op_sel:[1,1,0] op_sel_hi:[1,0,1] neg_lo:[1,0,0]
    v_cvt_pk_f16_f32 v145, v136, v137
    ds_write_b32 v92, v145 offset:3808
    v_pk_mul_f32 v[134:135], v[116:117], v[104:105] op_sel:[0,0] op_sel_hi:[0,1]
    v_pk_fma_f32 v[140:141], v[116:117], v[100:101], v[140:141] op_sel:[1,1,0] op_sel_hi:[1,0,1] neg_lo:[1,0,0]
    v_cvt_pk_f16_f32 v142, v138, v139
    ds_write_b32 v92, v142 offset:4080
    v_pk_mul_f32 v[136:137], v[116:117], v[108:109] op_sel:[0,0] op_sel_hi:[0,1]
    v_pk_fma_f32 v[134:135], v[116:117], v[104:105], v[134:135] op_sel:[1,1,0] op_sel_hi:[1,0,1] neg_lo:[1,0,0]
    v_cvt_pk_f16_f32 v143, v140, v141
    ds_write_b32 v92, v143 offset:4624
    v_pk_mul_f32 v[138:139], v[118:119], v[100:101] op_sel:[0,0] op_sel_hi:[0,1]
    v_pk_fma_f32 v[136:137], v[116:117], v[108:109], v[136:137] op_sel:[1,1,0] op_sel_hi:[1,0,1] neg_lo:[1,0,0]
    v_cvt_pk_f16_f32 v144, v134, v135
    ds_write_b32 v92, v144 offset:4896
    v_pk_mul_f32 v[140:141], v[118:119], v[104:105] op_sel:[0,0] op_sel_hi:[0,1]
    v_pk_fma_f32 v[138:139], v[118:119], v[100:101], v[138:139] op_sel:[1,1,0] op_sel_hi:[1,0,1] neg_lo:[1,0,0]
    v_cvt_pk_f16_f32 v145, v136, v137
    ds_write_b32 v92, v145 offset:5168
    v_pk_mul_f32 v[134:135], v[118:119], v[108:109] op_sel:[0,0] op_sel_hi:[0,1]
    v_pk_fma_f32 v[140:141], v[118:119], v[104:105], v[140:141] op_sel:[1,1,0] op_sel_hi:[1,0,1] neg_lo:[1,0,0]
    v_cvt_pk_f16_f32 v142, v138, v139
    ds_write_b32 v92, v142 offset:5712
    v_pk_mul_f32 v[136:137], v[120:121], v[104:105] op_sel:[0,0] op_sel_hi:[0,1]
    v_pk_fma_f32 v[134:135], v[118:119], v[108:109], v[134:135] op_sel:[1,1,0] op_sel_hi:[1,0,1] neg_lo:[1,0,0]
    v_cvt_pk_f16_f32 v143, v140, v141
    ds_write_b32 v92, v143 offset:5984
    v_pk_mul_f32 v[138:139], v[122:123], v[104:105] op_sel:[0,0] op_sel_hi:[0,1]
    v_pk_fma_f32 v[136:137], v[120:121], v[104:105], v[136:137] op_sel:[1,1,0] op_sel_hi:[1,0,1] neg_lo:[1,0,0]
    v_cvt_pk_f16_f32 v144, v134, v135
    ds_write_b32 v92, v144 offset:6256
    v_pk_mul_f32 v[140:141], v[124:125], v[104:105] op_sel:[0,0] op_sel_hi:[0,1]
    v_pk_fma_f32 v[138:139], v[122:123], v[104:105], v[138:139] op_sel:[1,1,0] op_sel_hi:[1,0,1] neg_lo:[1,0,0]
    v_cvt_pk_f16_f32 v145, v136, v137
    ds_write_b32 v92, v145 offset:6800
    v_pk_mul_f32 v[134:135], v[126:127], v[104:105] op_sel:[0,0] op_sel_hi:[0,1]
    v_pk_fma_f32 v[140:141], v[124:125], v[104:105], v[140:141] op_sel:[1,1,0] op_sel_hi:[1,0,1] neg_lo:[1,0,0]
    v_cvt_pk_f16_f32 v142, v138, v139
    ds_write_b32 v92, v142 offset:7344
    v_pk_mul_f32 v[136:137], v[128:129], v[114:115] op_sel:[0,0] op_sel_hi:[0,1]
    v_pk_fma_f32 v[134:135], v[126:127], v[104:105], v[134:135] op_sel:[1,1,0] op_sel_hi:[1,0,1] neg_lo:[1,0,0]
    v_cvt_pk_f16_f32 v143, v140, v141
    ds_write_b32 v92, v143 offset:7888
    v_lshlrev_b32 v7, 6, v2
    v_lshl_add_u32 v7, v3, 4, v7
    v_mov_b32 v156, v22
    v_mov_b32 v157, v24
    v_mov_b32 v158, v26
    v_mov_b32 v159, v28
    buffer_store_dwordx4 v[156:159], v7, s[48:51], s82 offen sc1
    v_mov_b32 v160, v23
    v_mov_b32 v161, v25
    v_mov_b32 v162, v27
    v_mov_b32 v163, v29
    buffer_store_dwordx4 v[160:163], v7, s[48:51], s82 offen offset:1024 sc1
    s_mov_b32 s8, 0x3f803f80
    v_dot2_f32_bf16 v164, v30, s8, 0
    v_dot2_f32_bf16 v166, v30, v30, 0
    v_dot2_f32_bf16 v165, v34, s8, 0
    v_dot2_f32_bf16 v167, v34, v34, 0
    v_dot2_f32_bf16 v164, v31, s8, v164
    v_dot2_f32_bf16 v166, v31, v31, v166
    v_dot2_f32_bf16 v165, v35, s8, v165
    v_dot2_f32_bf16 v167, v35, v35, v167
    v_dot2_f32_bf16 v164, v32, s8, v164
    v_dot2_f32_bf16 v166, v32, v32, v166
    v_dot2_f32_bf16 v165, v36, s8, v165
    v_dot2_f32_bf16 v167, v36, v36, v167
    v_dot2_f32_bf16 v164, v33, s8, v164
    v_dot2_f32_bf16 v166, v33, v33, v166
    v_dot2_f32_bf16 v165, v37, s8, v165
    v_dot2_f32_bf16 v167, v37, v37, v167
    s_nop 1
    v_permlane32_swap_b32 v164, v165
    v_permlane32_swap_b32 v166, v167
    v_add_f32 v164, v164, v165
    v_add_f32 v166, v166, v167
    s_nop 1
    v_permlane16_swap_b32 v164, v166
    v_add_f32 v164, v164, v166
    s_nop 1
    v_add_f32_dpp v164, v164, v164 row_ror:8 row_mask:0xf bank_mask:0xf
    s_nop 1
    v_add_f32_dpp v164, v164, v164 row_ror:4 row_mask:0xf bank_mask:0xf
    s_nop 1
    v_add_f32_dpp v164, v164, v164 row_ror:2 row_mask:0xf bank_mask:0xf
    s_nop 1
    v_add_f32_dpp v164, v164, v164 row_ror:1 row_mask:0xf bank_mask:0xf
    v_mov_b32 v165, v164
    s_nop 1
    v_permlane16_swap_b32 v164, v165
    v_mul_f32 v164, 0x3b000000, v164
    v_mul_f32 v165, 0x3b000000, v165
    v_fma_f32 v165, -v164, v164, v165
    v_max_f32 v165, 0, v165
    v_cvt_pk_bf16_f32 v165, v165, v165
    v_lshlrev_b32 v165, 16, v165
    v_add_f32 v165, 0x3727c5ac, v165
    v_cvt_pk_bf16_f32 v165, v165, v165
    v_lshlrev_b32 v165, 16, v165
    v_sqrt_f32 v165, v165
    s_nop 0
    v_cvt_pk_bf16_f32 v164, v164, v165
    v_lshrrev_b32 v4, 3, v1
    s_lshr_b32 s8, s80, 8
    s_add_u32 s8, s8, 18874368
    s_mov_b32 exec_lo, 1
    s_mov_b32 exec_hi, 1
    buffer_store_dword v164, v4, s[48:51], s8 offen sc1
    s_mov_b64 exec, -1
    v_pk_mul_f32 v[138:139], v[128:129], v[116:117] op_sel:[0,0] op_sel_hi:[0,1]
    v_pk_fma_f32 v[136:137], v[128:129], v[114:115], v[136:137] op_sel:[1,1,0] op_sel_hi:[1,0,1] neg_lo:[1,0,0]
    v_cvt_pk_f16_f32 v144, v134, v135
    ds_write_b32 v92, v144 offset:8432
    v_pk_mul_f32 v[140:141], v[128:129], v[118:119] op_sel:[0,0] op_sel_hi:[0,1]
    v_pk_fma_f32 v[138:139], v[128:129], v[116:117], v[138:139] op_sel:[1,1,0] op_sel_hi:[1,0,1] neg_lo:[1,0,0]
    v_cvt_pk_f16_f32 v145, v136, v137
    ds_write_b32 v92, v145 offset:8976
    v_pk_mul_f32 v[134:135], v[128:129], v[120:121] op_sel:[0,0] op_sel_hi:[0,1]
    v_pk_fma_f32 v[140:141], v[128:129], v[118:119], v[140:141] op_sel:[1,1,0] op_sel_hi:[1,0,1] neg_lo:[1,0,0]
    v_cvt_pk_f16_f32 v142, v138, v139
    ds_write_b32 v92, v142 offset:9248
    v_pk_mul_f32 v[136:137], v[128:129], v[122:123] op_sel:[0,0] op_sel_hi:[0,1]
    v_pk_fma_f32 v[134:135], v[128:129], v[120:121], v[134:135] op_sel:[1,1,0] op_sel_hi:[1,0,1] neg_lo:[1,0,0]
    v_cvt_pk_f16_f32 v143, v140, v141
    ds_write_b32 v92, v143 offset:9520
    v_pk_mul_f32 v[138:139], v[128:129], v[124:125] op_sel:[0,0] op_sel_hi:[0,1]
    v_pk_fma_f32 v[136:137], v[128:129], v[122:123], v[136:137] op_sel:[1,1,0] op_sel_hi:[1,0,1] neg_lo:[1,0,0]
    v_cvt_pk_f16_f32 v144, v134, v135
    ds_write_b32 v92, v144 offset:9792
    v_pk_mul_f32 v[140:141], v[128:129], v[126:127] op_sel:[0,0] op_sel_hi:[0,1]
    v_pk_fma_f32 v[138:139], v[128:129], v[124:125], v[138:139] op_sel:[1,1,0] op_sel_hi:[1,0,1] neg_lo:[1,0,0]
    v_cvt_pk_f16_f32 v145, v136, v137
    ds_write_b32 v92, v145 offset:10064
    v_pk_mul_f32 v[134:135], v[128:129], v[128:129] op_sel:[0,0] op_sel_hi:[0,1]
    v_pk_fma_f32 v[140:141], v[128:129], v[126:127], v[140:141] op_sel:[1,1,0] op_sel_hi:[1,0,1] neg_lo:[1,0,0]
    v_cvt_pk_f16_f32 v142, v138, v139
    ds_write_b32 v92, v142 offset:10336
    v_pk_fma_f32 v[134:135], v[128:129], v[128:129], v[134:135] op_sel:[1,1,0] op_sel_hi:[1,0,1] neg_lo:[1,0,0]
    v_cvt_pk_f16_f32 v143, v140, v141
    ds_write_b32 v92, v143 offset:10608
    v_cvt_pk_f16_f32 v144, v134, v135
    ds_write_b32 v92, v144 offset:10880
    s_waitcnt vmcnt(11)
    v_dot2_f32_bf16 v20, v38, v148, 0
    v_dot2_f32_bf16 v21, v38, v152, 0
    v_dot2_f32_bf16 v22, v39, v148, 0
    v_dot2_f32_bf16 v23, v39, v152, 0
    v_dot2_f32_bf16 v24, v40, v148, 0
    v_dot2_f32_bf16 v25, v40, v152, 0
    v_dot2_f32_bf16 v26, v41, v148, 0
    v_dot2_f32_bf16 v27, v41, v152, 0
    s_waitcnt vmcnt(10)
    v_dot2_f32_bf16 v20, v42, v149, v20
    v_dot2_f32_bf16 v21, v42, v153, v21
    v_dot2_f32_bf16 v22, v43, v149, v22
    v_dot2_f32_bf16 v23, v43, v153, v23
    v_dot2_f32_bf16 v24, v44, v149, v24
    v_dot2_f32_bf16 v25, v44, v153, v25
    v_dot2_f32_bf16 v26, v45, v149, v26
    v_dot2_f32_bf16 v27, v45, v153, v27
    s_waitcnt vmcnt(9)
    v_dot2_f32_bf16 v20, v46, v150, v20
    v_dot2_f32_bf16 v21, v46, v154, v21
    v_dot2_f32_bf16 v22, v47, v150, v22
    v_dot2_f32_bf16 v23, v47, v154, v23
    v_dot2_f32_bf16 v24, v48, v150, v24
    v_dot2_f32_bf16 v25, v48, v154, v25
    v_dot2_f32_bf16 v26, v49, v150, v26
    v_dot2_f32_bf16 v27, v49, v154, v27
    s_waitcnt vmcnt(8)
    v_dot2_f32_bf16 v20, v50, v151, v20
    v_dot2_f32_bf16 v21, v50, v155, v21
    v_dot2_f32_bf16 v22, v51, v151, v22
    v_dot2_f32_bf16 v23, v51, v155, v23
    v_dot2_f32_bf16 v24, v52, v151, v24
    v_dot2_f32_bf16 v25, v52, v155, v25
    v_dot2_f32_bf16 v26, v53, v151, v26
    v_dot2_f32_bf16 v27, v53, v155, v27
    v_and_b32 v4, 7, v0
    v_lshlrev_b32 v4, 5, v4
    v_lshl_add_u32 v4, v3, 3, v4
    v_permlane32_swap_b32 v20, v24
    v_permlane32_swap_b32 v21, v25
    v_permlane32_swap_b32 v22, v26
    v_permlane32_swap_b32 v23, v27
    v_add_f32 v20, v20, v24
    v_add_f32 v21, v21, v25
    v_add_f32 v22, v22, v26
    v_add_f32 v23, v23, v27
    s_nop 0
    v_permlane16_swap_b32 v20, v22
    v_permlane16_swap_b32 v21, v23
    v_add_f32 v20, v20, v22
    v_add_f32 v21, v21, v23
    s_nop 0
    v_add_f32_dpp v20, v20, v20 row_ror:8 row_mask:0xf bank_mask:0xf
    v_add_f32_dpp v21, v21, v21 row_ror:8 row_mask:0xf bank_mask:0xf
    v_mov_b32 v12, v4
    s_lshl_b32 s8, s5, 8
    v_add_u32 v4, s8, v4
    ds_write_b64 v4, v[20:21] offset:32768
    s_waitcnt lgkmcnt(0)
    s_barrier
    ds_read_b64 v[20:21], v12 offset:32768
    ds_read_b64 v[22:23], v12 offset:33024
    ds_read_b64 v[24:25], v12 offset:33280
    ds_read_b64 v[26:27], v12 offset:33536
    s_waitcnt lgkmcnt(2)
    v_pk_add_f32 v[20:21], v[20:21], v[22:23]
    s_waitcnt lgkmcnt(0)
    v_pk_add_f32 v[24:25], v[24:25], v[26:27]
    v_pk_add_f32 v[20:21], v[20:21], v[24:25]
    s_mov_b32 exec_lo, 0x00ff00ff
    s_mov_b32 exec_hi, 0x00ff00ff
    buffer_store_dwordx2 v[20:21], v12, s[48:51], s93 offen sc1
    s_mov_b64 exec, -1
    ds_read_b128 v[148:151], v93 offset:11152
    ds_read_b128 v[152:155], v93 offset:0
    ds_read_b128 v[156:159], v93 offset:4352
    ds_read_b128 v[160:163], v93 offset:8704
    ds_read_b128 v[164:167], v93 offset:11216
    ds_read_b128 v[168:171], v93 offset:64
    ds_read_b128 v[172:175], v93 offset:4416
    ds_read_b128 v[176:179], v93 offset:8768
    ds_read_b128 v[180:183], v93 offset:11280
    ds_read_b128 v[184:187], v93 offset:128
    ds_read_b128 v[188:191], v93 offset:4480
    ds_read_b128 v[192:195], v93 offset:8832
    ds_read_b128 v[196:199], v93 offset:11344
    ds_read_b128 v[200:203], v93 offset:192
    ds_read_b128 v[204:207], v93 offset:4544
    ds_read_b128 v[208:211], v93 offset:8896
    s_waitcnt lgkmcnt(14)
    v_mfma_f32_16x16x32_f16 v[20:23], v[152:155], v[148:151], 0
    s_waitcnt lgkmcnt(13)
    v_mfma_f32_16x16x32_f16 v[24:27], v[156:159], v[148:151], 0
    s_waitcnt lgkmcnt(12)
    v_mfma_f32_16x16x32_f16 v[28:31], v[160:163], v[148:151], 0
    s_waitcnt lgkmcnt(10)
    v_mfma_f32_16x16x32_f16 v[20:23], v[168:171], v[164:167], v[20:23]
    s_waitcnt lgkmcnt(9)
    v_mfma_f32_16x16x32_f16 v[24:27], v[172:175], v[164:167], v[24:27]
    s_waitcnt lgkmcnt(8)
    v_mfma_f32_16x16x32_f16 v[28:31], v[176:179], v[164:167], v[28:31]
    s_waitcnt lgkmcnt(6)
    v_mfma_f32_16x16x32_f16 v[20:23], v[184:187], v[180:183], v[20:23]
    s_waitcnt lgkmcnt(5)
    v_mfma_f32_16x16x32_f16 v[24:27], v[188:191], v[180:183], v[24:27]
    s_waitcnt lgkmcnt(4)
    v_mfma_f32_16x16x32_f16 v[28:31], v[192:195], v[180:183], v[28:31]
    s_waitcnt lgkmcnt(2)
    v_mfma_f32_16x16x32_f16 v[20:23], v[200:203], v[196:199], v[20:23]
    s_waitcnt lgkmcnt(1)
    v_mfma_f32_16x16x32_f16 v[24:27], v[204:207], v[196:199], v[24:27]
    s_waitcnt lgkmcnt(0)
    v_mfma_f32_16x16x32_f16 v[28:31], v[208:211], v[196:199], v[28:31]
    s_xor_b32 s8, s5, 1
    s_mul_i32 s8, s8, 15504
    s_add_u32 s8, s8, 101824
    v_add_u32 v164, s92, v6
    v_add_u32 v165, s8, v6
    s_waitcnt vmcnt(8)
    v_pk_mul_f32 v[20:21], v[20:21], v[58:59] op_sel:[0,0] op_sel_hi:[1,0]
    v_pk_mul_f32 v[22:23], v[22:23], v[58:59] op_sel:[0,0] op_sel_hi:[1,0]
    ds_write_b128 v164, v[20:23] offset:0
    v_pk_mul_f32 v[24:25], v[24:25], v[58:59] op_sel:[0,0] op_sel_hi:[1,0]
    v_pk_mul_f32 v[26:27], v[26:27], v[58:59] op_sel:[0,0] op_sel_hi:[1,0]
    ds_write_b128 v164, v[24:27] offset:1024
    v_pk_mul_f32 v[28:29], v[28:29], v[58:59] op_sel:[0,0] op_sel_hi:[1,0]
    v_pk_mul_f32 v[30:31], v[30:31], v[58:59] op_sel:[0,0] op_sel_hi:[1,0]
    ds_write_b128 v164, v[28:31] offset:2048
    s_waitcnt vmcnt(7)
    v_add_u32 v18, 0x9e3779b9, v18
    v_or_b32 v18, 1, v18
    s_waitcnt vmcnt(0)
    s_waitcnt lgkmcnt(0)
    s_barrier
    s_mov_b32 s8, 19005440
    s_cmp_eq_u32 s5, 0
    s_cselect_b64 exec, 0xff, 0
    buffer_store_dword v18, v60, s[48:51], s8 offen sc1
    s_mov_b64 exec, -1
    s_mul_i32 s8, s2, 9363
    s_lshr_b32 s8, s8, 16
    s_mul_i32 s9, s8, 7
    s_sub_u32 s9, s2, s9
    s_mul_i32 s8, s8, 56
    s_lshl_b32 s10, s9, 2
    s_lshl_b32 s11, s9, 3
    s_cmp_lt_u32 s9, 4
    s_cselect_b32 s10, s10, s11
    s_cselect_b32 s11, 16, 4
    s_add_u32 s8, s8, s10
    s_add_u32 s9, s8, s11
    s_lshl_b32 s8, s8, 10
    s_lshl_b32 s9, s9, 10
    s_cmp_lt_u32 s2, 224
    s_cselect_b32 s8, s8, 1073741824
    s_cselect_b32 s9, s9, 1073741824
    v_lshlrev_b32 v5, 2, v0
    buffer_load_dword v32, v5, s[68:71], s8 offen offset:0 nt
    buffer_load_dword v33, v5, s[68:71], s8 offen offset:1024 nt
    buffer_load_dword v34, v5, s[68:71], s8 offen offset:2048 nt
    buffer_load_dword v35, v5, s[68:71], s8 offen offset:3072 nt
    buffer_load_dword v36, v5, s[68:71], s9 offen offset:0 nt
    buffer_load_dword v37, v5, s[68:71], s9 offen offset:1024 nt
    buffer_load_dword v38, v5, s[68:71], s9 offen offset:2048 nt
    buffer_load_dword v39, v5, s[68:71], s9 offen offset:3072 nt
    ds_read_b128 v[148:151], v165 offset:0
    ds_read_b128 v[152:155], v165 offset:1024
    ds_read_b128 v[156:159], v165 offset:2048
    s_add_u32 m0, s14, 0
    s_nop 0
    buffer_load_dwordx4 v64, s[52:55], s90 offen lds
    s_waitcnt lgkmcnt(2)
    v_pk_add_f32 v[20:21], v[20:21], v[148:149]
    v_pk_add_f32 v[22:23], v[22:23], v[150:151]
    v_cvt_pk_bf16_f32 v20, v20, v21
    v_cvt_pk_bf16_f32 v21, v22, v23
    ds_write_b64 v94, v[20:21]
    s_add_u32 m0, s14, 4096
    s_nop 0
    buffer_load_dwordx4 v65, s[52:55], s90 offen lds
    s_waitcnt lgkmcnt(2)
    v_pk_add_f32 v[24:25], v[24:25], v[152:153]
    v_pk_add_f32 v[26:27], v[26:27], v[154:155]
    v_cvt_pk_bf16_f32 v24, v24, v25
    v_cvt_pk_bf16_f32 v25, v26, v27
    ds_write_b32 v95, v24 offset:512
    ds_write_b32 v96, v25 offset:512
    s_add_u32 m0, s14, 8192
    s_nop 0
    buffer_load_dwordx4 v66, s[52:55], s90 offen lds
    s_waitcnt lgkmcnt(3)
    v_pk_add_f32 v[28:29], v[28:29], v[156:157]
    v_pk_add_f32 v[30:31], v[30:31], v[158:159]
    v_cvt_pk_bf16_f32 v28, v28, v29
    v_cvt_pk_bf16_f32 v29, v30, v31
    ds_write_b16 v97, v28 offset:1024
    ds_write_b16_d16_hi v97, v28 offset:1056
    ds_write_b16 v97, v29 offset:1088
    ds_write_b16_d16_hi v97, v29 offset:1120
    s_add_u32 m0, s14, 12288
    s_nop 0
    buffer_load_dwordx4 v67, s[52:55], s90 offen lds
    s_waitcnt lgkmcnt(0)
    s_barrier
    ds_read_u16 v148, v72
    ds_read_u16 v149, v73
    ds_read_u16 v150, v74
    ds_read_u16 v151, v75
    ds_read_u16 v152, v76
    ds_read_u16 v153, v77
    ds_read_u16 v154, v78
    ds_read_u16 v155, v79
    ds_read_u16 v156, v80
    s_add_u32 m0, s14, 16384
    s_nop 0
    buffer_load_dwordx4 v68, s[52:55], s90 offen lds
    ds_read_u16 v157, v81
    ds_read_u16 v158, v82
    ds_read_u16 v159, v83
    ds_read_u16 v160, v84
    ds_read_u16 v161, v85
    ds_read_u16 v162, v86
    ds_read_u16 v163, v87
    ds_read_u16 v164, v88
    ds_read_u16 v165, v89
    s_add_u32 m0, s14, 20480
    s_nop 0
    buffer_load_dwordx4 v69, s[52:55], s90 offen lds
    ds_write_b32 v98, v14
    v_cmp_le_u32 vcc, 8, v1
    v_mov_b32 v20, 4132
    s_lshr_b32 s8, s5, 1
    s_mul_i32 s8, s8, 8320
    s_add_u32 s8, s8, 118784
    v_cndmask_b32 v20, 0, v20, vcc
    v_lshl_add_u32 v21, v1, 2, s8
    v_add_u32 v20, v20, v21
    s_mov_b64 exec, 0x7fff
    ds_write_b32 v20, v14
    s_mov_b64 exec, -1
    s_waitcnt lgkmcnt(15)
    v_lshl_or_b32 v168, v150, 16, v149
    v_lshl_or_b32 v169, v152, 16, v151
    s_waitcnt lgkmcnt(13)
    v_lshl_or_b32 v170, v154, 16, v153
    s_waitcnt lgkmcnt(11)
    v_lshl_or_b32 v171, v156, 16, v155
    ds_write_b128 v91, v[168:171] offset:0
    v_lshl_or_b32 v172, v149, 16, v148
    v_lshl_or_b32 v173, v151, 16, v150
    v_lshl_or_b32 v174, v153, 16, v152
    v_lshl_or_b32 v175, v155, 16, v154
    ds_write_b128 v91, v[172:175] offset:4160
    s_add_u32 m0, s14, 24576
    s_nop 0
    buffer_load_dwordx4 v70, s[52:55], s90 offen lds
    s_waitcnt lgkmcnt(10)
    v_lshl_or_b32 v176, v159, 16, v158
    s_waitcnt lgkmcnt(8)
    v_lshl_or_b32 v177, v161, 16, v160
    s_waitcnt lgkmcnt(6)
    v_lshl_or_b32 v178, v163, 16, v162
    s_waitcnt lgkmcnt(4)
    v_lshl_or_b32 v179, v165, 16, v164
    ds_write_b128 v91, v[176:179] offset:2048
    v_lshl_or_b32 v180, v158, 16, v157
    v_lshl_or_b32 v181, v160, 16, v159
    v_lshl_or_b32 v182, v162, 16, v161
    v_lshl_or_b32 v183, v164, 16, v163
    ds_write_b128 v91, v[180:183] offset:6208
    s_add_u32 m0, s14, 57344
    s_nop 0
    buffer_load_dwordx4 v64, s[56:59], s90 offen lds
    s_bitcmp1_b32 s5, 0
    s_mov_b32 exec_lo, 0
    s_cselect_b32 exec_hi, 0x80000000, 0
    ds_write_b32 v91, v165 offset:6224
    s_mov_b64 exec, -1
    v_lshrrev_b32 v12, 2, v1
    v_and_b32 v4, 3, v0
    v_mul_u32_u24 v12, 16512, v12
    v_lshl_add_u32 v12, v4, 4, v12
    s_and_b32 s8, s4, 1
    s_lshl_b32 s8, s8, 4
    s_lshr_b32 s9, s4, 1
    s_add_u32 s8, s8, s9
    s_lshl_b32 s9, s3, 5
    s_add_u32 s8, s8, s9
    s_lshl_b32 s8, s8, 6
    s_mul_i32 s9, s5, 528384
    s_add_u32 s80, s8, s9
    s_add_u32 s81, s80, 264192
    s_lshl_b32 s8, s5, 11
    s_add_u32 s82, s8, 18874368
    s_mul_i32 s9, s76, 8448
    s_add_u32 s8, s8, s9
    s_add_u32 s83, s8, 2359296
    s_add_u32 s84, s8, 4718592
    s_lshl_b32 s8, s76, 3
    s_add_u32 s85, s8, 19333120
    s_lshl_b32 s8, s76, 2
    s_add_u32 s8, s8, 19095552
    s_cmp_eq_u32 s5, 0
    s_cselect_b32 s86, s8, 1073741824
    s_lshr_b32 s8, s4, 2
    s_mul_i32 s8, s8, 229376
    s_mul_i32 s9, s5, 57344
    s_add_u32 s8, s8, s9
    s_add_u32 s94, s8, 16777216
    v_and_b32 v4, 3, v0
    v_mul_u32_u24 v63, 12288, v4
    s_movk_i32 s8, 1024
    v_lshlrev_b32 v4, v3, s8
    v_and_b32 v4, 0xfffff800, v4
    v_add_u32 v58, v4, v63
    v_bfe_u32 v4, v0, 4, 1
    v_cvt_f32_u32 v71, v4
    v_mul_u32_u24 v16, 12288, v3
    v_bfe_u32 v4, v0, 6, 1
    v_lshl_add_u32 v16, v4, 7, v16
    v_lshl_add_u32 v16, v2, 3, v16
    s_lshl_b32 s8, s77, 8
    s_cmp_lt_u32 s5, 2
    s_mov_b32 s9, 19339264
    s_cselect_b32 s9, 19341312, s9
    s_add_u32 s93, s8, s9
    s_lshl_b32 s8, s78, 13
    s_lshl_b32 s9, s77, 10
    s_add_u32 s8, s8, s9
    s_add_u32 s95, s8, 19529728
    s_lshr_b32 s8, s5, 1
    s_and_b32 s9, s5, 1
    s_lshl_b32 s9, s9, 8
    s_mul_i32 s10, s8, 8320
    s_sub_u32 s10, s10, s9
    s_add_u32 s10, s10, 118094
    s_mul_i32 s11, s8, 4608
    s_sub_u32 s11, s11, s9
    s_add_u32 s11, s11, 131664
    v_lshlrev_b32 v4, 4, v3
    v_lshlrev_b32 v15, 5, v2
    v_sub_u32 v15, v15, v4
    v_add_u32 v15, s11, v15
    v_lshl_add_u32 v4, v2, 1, v4
    v_sub_u32 v8, s10, v4
    v_and_b32 v4, 1, v0
    v_cmp_eq_u32 vcc, 0, v4
    v_add_u32 v4, 4162, v8
    s_add_u32 s8, s79, 131840
    v_cndmask_b32 v8, v8, v4, vcc
    v_lshl_add_u32 v19, v1, 3, s8
    v_subrev_u32 v9, 1024, v8
    v_subrev_u32 v10, 2048, v8
    v_subrev_u32 v11, 3072, v8
    s_cmp_lg_u32 s5, 0
    s_cbranch_scc1 L_pend2
    s_mov_b32 s6, 32768
L_poll1:
    buffer_load_dwordx4 v[20:23], v13, s[48:51], 0 offen sc1
    s_waitcnt vmcnt(0)
    v_xor_b32 v20, v20, v18
    v_xor_b32 v21, v21, v18
    v_xor_b32 v22, v22, v18
    v_xor_b32 v23, v23, v18
    v_or3_b32 v20, v20, v21, v22
    v_or_b32 v20, v20, v23
    v_cmp_ne_u32 vcc, 0, v20
    s_cbranch_vccz L_pend2
    s_sub_u32 s6, s6, 1
    s_cmp_lg_u32 s6, 0
    s_cbranch_scc1 L_poll1
L_pend2:
    s_nop 0
    s_waitcnt lgkmcnt(0)
    s_barrier
    s_mov_b32 exec_lo, 0x000f000f
    s_mov_b32 exec_hi, 0x000f000f
    buffer_load_dwordx2 v[48:49], v58, s[48:51], s85 offen sc1
    s_mov_b64 exec, -1
    buffer_load_dwordx4 v[40:43], v6, s[48:51], s82 offen offset:0 sc1
    buffer_load_dwordx4 v[44:47], v6, s[48:51], s82 offen offset:1024 sc1
    buffer_load_dwordx4 v[24:27], v12, s[48:51], s80 offen sc1
    buffer_load_dwordx4 v[28:31], v12, s[48:51], s81 offen sc1
    s_add_u32 s85, s85, 10240
    s_cmp_eq_u32 s5, 0
    s_cselect_b32 s85, s85, 1073741824
    s_mov_b64 exec, 15
    buffer_load_dwordx2 v[50:51], v63, s[48:51], s85 offen sc1
    s_mov_b64 exec, -1
    buffer_load_dwordx2 v[136:137], v16, s[48:51], s93 offen sc1
    s_add_u32 s93, s93, 12288
    ds_read2_b32 v[72:73], v8 offset0:176 offset1:177
    ds_read2_b32 v[74:75], v8 offset0:178 offset1:179
    ds_read2_b32 v[76:77], v8 offset0:48 offset1:49
    ds_read2_b32 v[78:79], v8 offset0:50 offset1:51
    ds_read2_b32 v[80:81], v9 offset0:176 offset1:177
    ds_read2_b32 v[82:83], v9 offset0:178 offset1:179
    ds_read2_b32 v[84:85], v9 offset0:48 offset1:49
    ds_read2_b32 v[86:87], v9 offset0:50 offset1:51
    ds_read2_b32 v[88:89], v10 offset0:176 offset1:177
    ds_read2_b32 v[90:91], v10 offset0:178 offset1:179
    ds_read2_b32 v[92:93], v10 offset0:48 offset1:49
    ds_read2_b32 v[94:95], v10 offset0:50 offset1:51
    ds_read2_b32 v[96:97], v11 offset0:176 offset1:177
    ds_read2_b32 v[98:99], v11 offset0:178 offset1:179
    ds_read2_b32 v[100:101], v11 offset0:48 offset1:49
    ds_read2_b32 v[102:103], v11 offset0:50 offset1:51
    s_lshr_b32 s8, s2, 2
    s_lshl_b32 s8, s8, 12
    s_and_b32 s9, s2, 3
    s_lshl_b32 s9, s9, 8
    s_add_u32 s8, s8, s9
    s_add_u32 s8, s8, 16777216
    s_cmp_lt_u32 s2, 224
    s_cselect_b32 s8, s8, 1073741824
    s_mov_b32 s9, 0x05040100
    s_mov_b32 s10, 0x07060302
    v_lshrrev_b32 v12, 5, v0
    v_mul_u32_u24 v12, 229376, v12
    v_lshl_add_u32 v12, v2, 4, v12
    v_bfe_u32 v4, v0, 4, 1
    v_lshl_add_u32 v12, v4, 11, v12
    s_waitcnt vmcnt(21)
    v_perm_b32 v212, v33, v32, s9
    s_waitcnt vmcnt(19)
    v_perm_b32 v213, v35, v34, s9
    s_waitcnt vmcnt(17)
    v_perm_b32 v214, v37, v36, s9
    s_waitcnt vmcnt(15)
    v_perm_b32 v215, v39, v38, s9
    buffer_store_dwordx4 v[212:215], v12, s[48:51], s8 offen offset:0 sc1
    v_perm_b32 v216, v33, v32, s10
    v_perm_b32 v217, v35, v34, s10
    v_perm_b32 v218, v37, v36, s10
    v_perm_b32 v219, v39, v38, s10
    buffer_store_dwordx4 v[216:219], v12, s[48:51], s8 offen offset:1024 sc1
    s_waitcnt vmcnt(8)
    v_add_f32_dpp v48, v48, v48 quad_perm:[1,0,3,2] row_mask:0xf bank_mask:0xf
    v_add_f32_dpp v49, v49, v49 quad_perm:[1,0,3,2] row_mask:0xf bank_mask:0xf
    s_nop 0
    v_add_f32_dpp v48, v48, v48 quad_perm:[2,3,0,1] row_mask:0xf bank_mask:0xf
    v_add_f32_dpp v49, v49, v49 quad_perm:[2,3,0,1] row_mask:0xf bank_mask:0xf
    v_cvt_pk_bf16_f32 v48, v48, v49
    v_and_b32 v49, 0xffff0000, v48
    v_lshlrev_b32 v48, 16, v48
    v_add_f32 v49, v49, v71
    v_add_f32 v48, v48, v71
    v_cvt_pk_bf16_f32 v48, v48, v49
    v_and_b32 v49, 0xffff0000, v48
    v_lshlrev_b32 v48, 16, v48
    s_waitcnt vmcnt(7)
    v_lshlrev_b32 v32, 16, v40
    v_and_b32 v228, 0xffff0000, v40
    v_lshlrev_b32 v33, 16, v41
    v_and_b32 v229, 0xffff0000, v41
    v_lshlrev_b32 v34, 16, v42
    v_and_b32 v230, 0xffff0000, v42
    v_lshlrev_b32 v35, 16, v43
    v_and_b32 v231, 0xffff0000, v43
    v_readlane_b32 s8, v48, 0
    v_readlane_b32 s9, v49, 0
    v_readlane_b32 s10, v48, 16
    v_readlane_b32 s11, v49, 16
    v_readlane_b32 s44, v48, 32
    v_readlane_b32 s45, v49, 32
    v_readlane_b32 s46, v48, 48
    v_readlane_b32 s47, v49, 48
    s_waitcnt vmcnt(6)
    v_lshlrev_b32 v36, 16, v44
    v_and_b32 v232, 0xffff0000, v44
    v_lshlrev_b32 v37, 16, v45
    v_and_b32 v233, 0xffff0000, v45
    v_lshlrev_b32 v38, 16, v46
    v_and_b32 v234, 0xffff0000, v46
    v_lshlrev_b32 v39, 16, v47
    v_and_b32 v235, 0xffff0000, v47
    v_mov_b32 v52, s8
    v_mov_b32 v53, s9
    v_rcp_f32 v228, v228
    v_rcp_f32 v229, v229
    v_rcp_f32 v230, v230
    v_rcp_f32 v231, v231
    v_rcp_f32 v232, v232
    v_rcp_f32 v233, v233
    v_rcp_f32 v234, v234
    v_rcp_f32 v235, v235
    s_waitcnt vmcnt(5)
    v_lshlrev_b32 v212, 16, v24
    v_and_b32 v216, 0xffff0000, v24
    v_lshlrev_b32 v213, 16, v25
    v_and_b32 v217, 0xffff0000, v25
    v_lshlrev_b32 v214, 16, v26
    v_and_b32 v218, 0xffff0000, v26
    v_lshlrev_b32 v215, 16, v27
    v_and_b32 v219, 0xffff0000, v27
    s_waitcnt vmcnt(4)
    v_lshlrev_b32 v220, 16, v28
    v_and_b32 v224, 0xffff0000, v28
    v_lshlrev_b32 v221, 16, v29
    v_and_b32 v225, 0xffff0000, v29
    v_lshlrev_b32 v222, 16, v30
    v_and_b32 v226, 0xffff0000, v30
    v_lshlrev_b32 v223, 16, v31
    v_and_b32 v227, 0xffff0000, v31
    v_pk_add_f32 v[236:237], v[212:213], v[32:33] neg_lo:[0,1] neg_hi:[0,1]
    v_pk_add_f32 v[238:239], v[214:215], v[34:35] neg_lo:[0,1] neg_hi:[0,1]
    v_pk_mul_f32 v[236:237], v[236:237], v[228:229]
    v_pk_mul_f32 v[238:239], v[238:239], v[230:231]
    v_pk_fma_f32 v[236:237], v[236:237], s[10:11], v[52:53] op_sel:[0,0,0] op_sel_hi:[1,0,0]
    v_pk_fma_f32 v[238:239], v[238:239], s[10:11], v[52:53] op_sel:[0,0,0] op_sel_hi:[1,0,0]
    v_cvt_pk_bf16_f32 v24, v236, v237
    v_cvt_pk_bf16_f32 v25, v238, v239
    ds_write_b64 v19, v[24:25] offset:0
    v_pk_add_f32 v[240:241], v[216:217], v[32:33] neg_lo:[0,1] neg_hi:[0,1]
    v_pk_add_f32 v[242:243], v[218:219], v[34:35] neg_lo:[0,1] neg_hi:[0,1]
    v_pk_mul_f32 v[240:241], v[240:241], v[228:229]
    v_pk_mul_f32 v[242:243], v[242:243], v[230:231]
    v_pk_fma_f32 v[240:241], v[240:241], s[10:11], v[52:53] op_sel:[0,1,1] op_sel_hi:[1,1,1]
    v_pk_fma_f32 v[242:243], v[242:243], s[10:11], v[52:53] op_sel:[0,1,1] op_sel_hi:[1,1,1]
    v_cvt_pk_bf16_f32 v26, v240, v241
    v_cvt_pk_bf16_f32 v27, v242, v243
    ds_write_b64 v19, v[26:27] offset:4608
    v_pk_add_f32 v[244:245], v[220:221], v[36:37] neg_lo:[0,1] neg_hi:[0,1]
    v_pk_add_f32 v[246:247], v[222:223], v[38:39] neg_lo:[0,1] neg_hi:[0,1]
    v_pk_mul_f32 v[244:245], v[244:245], v[232:233]
    v_pk_mul_f32 v[246:247], v[246:247], v[234:235]
    v_pk_fma_f32 v[244:245], v[244:245], s[10:11], v[52:53] op_sel:[0,0,0] op_sel_hi:[1,0,0]
    v_pk_fma_f32 v[246:247], v[246:247], s[10:11], v[52:53] op_sel:[0,0,0] op_sel_hi:[1,0,0]
    v_cvt_pk_bf16_f32 v28, v244, v245
    v_cvt_pk_bf16_f32 v29, v246, v247
    ds_write_b64 v19, v[28:29] offset:512
    v_pk_add_f32 v[248:249], v[224:225], v[36:37] neg_lo:[0,1] neg_hi:[0,1]
    v_pk_add_f32 v[250:251], v[226:227], v[38:39] neg_lo:[0,1] neg_hi:[0,1]
    v_pk_mul_f32 v[248:249], v[248:249], v[232:233]
    v_pk_mul_f32 v[250:251], v[250:251], v[234:235]
    v_pk_fma_f32 v[248:249], v[248:249], s[10:11], v[52:53] op_sel:[0,1,1] op_sel_hi:[1,1,1]
    v_pk_fma_f32 v[250:251], v[250:251], s[10:11], v[52:53] op_sel:[0,1,1] op_sel_hi:[1,1,1]
    v_cvt_pk_bf16_f32 v30, v248, v249
    v_cvt_pk_bf16_f32 v31, v250, v251
    ds_write_b64 v19, v[30:31] offset:5120
    s_waitcnt lgkmcnt(0)
    s_barrier
    ds_read_b128 v[104:107], v15 offset:192
    ds_read_b128 v[108:111], v15 offset:704
    ds_read_b128 v[112:115], v15 offset:1216
    ds_read_b128 v[116:119], v15 offset:1728
    ds_read_b128 v[120:123], v15 offset:2240
    ds_read_b128 v[124:127], v15 offset:2752
    ds_read_b128 v[128:131], v15 offset:3264
    ds_read_b128 v[132:135], v15 offset:3776
    s_waitcnt lgkmcnt(7)
    v_mfma_f32_16x16x32_bf16 a[224:227], v[72:75], v[104:107], 0
    ds_read2_b32 v[148:149], v8 offset0:160 offset1:161
    s_add_u32 m0, s14, 61440
    s_nop 0
    buffer_load_dwordx4 v65, s[56:59], s90 offen lds
    v_mfma_f32_16x16x32_bf16 a[228:231], v[76:79], v[104:107], 0
    ds_read2_b32 v[150:151], v8 offset0:162 offset1:163
    v_mfma_f32_16x16x32_bf16 a[232:235], v[80:83], v[104:107], 0
    ds_read2_b32 v[152:153], v8 offset0:32 offset1:33
    v_mfma_f32_16x16x32_bf16 a[236:239], v[84:87], v[104:107], 0
    ds_read2_b32 v[154:155], v8 offset0:34 offset1:35
    v_mfma_f32_16x16x32_bf16 a[240:243], v[88:91], v[104:107], 0
    ds_read2_b32 v[156:157], v9 offset0:160 offset1:161
    v_mfma_f32_16x16x32_bf16 a[244:247], v[92:95], v[104:107], 0
    ds_read2_b32 v[158:159], v9 offset0:162 offset1:163
    v_mfma_f32_16x16x32_bf16 a[248:251], v[96:99], v[104:107], 0
    ds_read2_b32 v[160:161], v9 offset0:32 offset1:33
    v_mfma_f32_16x16x32_bf16 a[252:255], v[100:103], v[104:107], 0
    ds_read2_b32 v[162:163], v9 offset0:34 offset1:35
    s_add_u32 m0, s14, 65536
    s_nop 0
    buffer_load_dwordx4 v66, s[56:59], s90 offen lds
    s_waitcnt lgkmcnt(14)
    v_mfma_f32_16x16x32_bf16 a[228:231], v[72:75], v[108:111], a[228:231]
    ds_read2_b32 v[164:165], v10 offset0:160 offset1:161
    v_mfma_f32_16x16x32_bf16 a[232:235], v[76:79], v[108:111], a[232:235]
    ds_read2_b32 v[166:167], v10 offset0:162 offset1:163
    v_mfma_f32_16x16x32_bf16 a[236:239], v[80:83], v[108:111], a[236:239]
    ds_read2_b32 v[168:169], v10 offset0:32 offset1:33
    v_mfma_f32_16x16x32_bf16 a[240:243], v[84:87], v[108:111], a[240:243]
    ds_read2_b32 v[170:171], v10 offset0:34 offset1:35
    v_mfma_f32_16x16x32_bf16 a[244:247], v[88:91], v[108:111], a[244:247]
    ds_read2_b32 v[172:173], v11 offset0:160 offset1:161
    v_mfma_f32_16x16x32_bf16 a[248:251], v[92:95], v[108:111], a[248:251]
    ds_read2_b32 v[174:175], v11 offset0:162 offset1:163
    v_mfma_f32_16x16x32_bf16 a[252:255], v[96:99], v[108:111], a[252:255]
    ds_read2_b32 v[176:177], v11 offset0:32 offset1:33
    s_add_u32 m0, s14, 69632
    s_nop 0
    buffer_load_dwordx4 v67, s[56:59], s90 offen lds
    s_waitcnt lgkmcnt(15)
    v_mfma_f32_16x16x32_bf16 a[232:235], v[72:75], v[112:115], a[232:235]
    ds_read2_b32 v[178:179], v11 offset0:34 offset1:35
    v_mfma_f32_16x16x32_bf16 a[236:239], v[76:79], v[112:115], a[236:239]
    ds_read_b128 v[180:183], v15 offset:128
    v_mfma_f32_16x16x32_bf16 a[240:243], v[80:83], v[112:115], a[240:243]
    ds_read_b128 v[184:187], v15 offset:640
    v_mfma_f32_16x16x32_bf16 a[244:247], v[84:87], v[112:115], a[244:247]
    ds_read_b128 v[188:191], v15 offset:1152
    v_mfma_f32_16x16x32_bf16 a[248:251], v[88:91], v[112:115], a[248:251]
    ds_read_b128 v[192:195], v15 offset:1664
    v_mfma_f32_16x16x32_bf16 a[252:255], v[92:95], v[112:115], a[252:255]
    ds_read_b128 v[196:199], v15 offset:2176
    v_mfma_f32_16x16x32_bf16 a[236:239], v[72:75], v[116:119], a[236:239]
    ds_read_b128 v[200:203], v15 offset:2688
    s_add_u32 m0, s14, 73728
    s_nop 0
    buffer_load_dwordx4 v68, s[56:59], s90 offen lds
    v_mfma_f32_16x16x32_bf16 a[240:243], v[76:79], v[116:119], a[240:243]
    ds_read_b128 v[204:207], v15 offset:3200
    v_mfma_f32_16x16x32_bf16 a[244:247], v[80:83], v[116:119], a[244:247]
    ds_read_b128 v[208:211], v15 offset:3712
    v_mfma_f32_16x16x32_bf16 a[248:251], v[84:87], v[116:119], a[248:251]
    v_lshlrev_b32 v54, 16, v59
    v_mfma_f32_16x16x32_bf16 a[252:255], v[88:91], v[116:119], a[252:255]
    v_and_b32 v55, 0xffff0000, v59
    v_mfma_f32_16x16x32_bf16 a[240:243], v[72:75], v[120:123], a[240:243]
    v_mul_f32_e64 v54, v54, s44
    v_mfma_f32_16x16x32_bf16 a[244:247], v[76:79], v[120:123], a[244:247]
    v_mul_f32_e64 v55, v55, s45
    v_mfma_f32_16x16x32_bf16 a[248:251], v[80:83], v[120:123], a[248:251]
    s_waitcnt vmcnt(7)
    v_add_f32_dpp v50, v50, v50 quad_perm:[1,0,3,2] row_mask:0xf bank_mask:0xf
    s_add_u32 m0, s14, 77824
    s_nop 0
    buffer_load_dwordx4 v69, s[56:59], s90 offen lds
    v_mfma_f32_16x16x32_bf16 a[252:255], v[84:87], v[120:123], a[252:255]
    s_cmp_lt_u32 s5, 2
    s_cselect_b32 s8, 1.0, 0
    v_mov_b32 v34, s8
    v_mfma_f32_16x16x32_bf16 a[244:247], v[72:75], v[124:127], a[244:247]
    v_add_f32_dpp v51, v51, v51 quad_perm:[1,0,3,2] row_mask:0xf bank_mask:0xf
    v_mfma_f32_16x16x32_bf16 a[248:251], v[76:79], v[124:127], a[248:251]
    s_waitcnt vmcnt(7)
    v_permlane32_swap_b32 v136, v137
    v_mfma_f32_16x16x32_bf16 a[252:255], v[80:83], v[124:127], a[252:255]
    v_add_f32_dpp v50, v50, v50 quad_perm:[2,3,0,1] row_mask:0xf bank_mask:0xf
    v_mfma_f32_16x16x32_bf16 a[248:251], v[72:75], v[128:131], a[248:251]
    s_lshl_b32 s8, s5, 6
    s_add_u32 s8, s8, 147456
    v_lshl_add_u32 v32, v2, 2, s8
    v_mfma_f32_16x16x32_bf16 a[252:255], v[76:79], v[128:131], a[252:255]
    v_add_f32_dpp v51, v51, v51 quad_perm:[2,3,0,1] row_mask:0xf bank_mask:0xf
    v_mfma_f32_16x16x32_bf16 a[252:255], v[72:75], v[132:135], a[252:255]
    v_add_f32 v136, v136, v137
    s_add_u32 m0, s14, 81920
    s_nop 0
    buffer_load_dwordx4 v70, s[56:59], s90 offen lds
    s_waitcnt lgkmcnt(7)
    v_mfma_f32_16x16x32_bf16 a[224:227], v[148:151], v[180:183], a[224:227]
    ds_read2_b32 v[72:73], v8 offset0:144 offset1:145
    v_mfma_f32_16x16x32_bf16 a[228:231], v[152:155], v[180:183], a[228:231]
    ds_read2_b32 v[74:75], v8 offset0:146 offset1:147
    v_mfma_f32_16x16x32_bf16 a[232:235], v[156:159], v[180:183], a[232:235]
    ds_read2_b32 v[76:77], v8 offset0:16 offset1:17
    v_mfma_f32_16x16x32_bf16 a[236:239], v[160:163], v[180:183], a[236:239]
    ds_read2_b32 v[78:79], v8 offset0:18 offset1:19
    v_mfma_f32_16x16x32_bf16 a[240:243], v[164:167], v[180:183], a[240:243]
    ds_read2_b32 v[80:81], v9 offset0:144 offset1:145
    v_mfma_f32_16x16x32_bf16 a[244:247], v[168:171], v[180:183], a[244:247]
    ds_read2_b32 v[82:83], v9 offset0:146 offset1:147
    v_mfma_f32_16x16x32_bf16 a[248:251], v[172:175], v[180:183], a[248:251]
    ds_read2_b32 v[84:85], v9 offset0:16 offset1:17
    s_add_u32 m0, s15, 0
    s_nop 0
    buffer_load_dwordx4 v64, s[52:55], s91 offen lds
    v_mfma_f32_16x16x32_bf16 a[252:255], v[176:179], v[180:183], a[252:255]
    ds_read2_b32 v[86:87], v9 offset0:18 offset1:19
    s_waitcnt lgkmcnt(14)
    v_mfma_f32_16x16x32_bf16 a[228:231], v[148:151], v[184:187], a[228:231]
    ds_read2_b32 v[88:89], v10 offset0:144 offset1:145
    v_mfma_f32_16x16x32_bf16 a[232:235], v[152:155], v[184:187], a[232:235]
    ds_read2_b32 v[90:91], v10 offset0:146 offset1:147
    v_mfma_f32_16x16x32_bf16 a[236:239], v[156:159], v[184:187], a[236:239]
    ds_read2_b32 v[92:93], v10 offset0:16 offset1:17
    v_mfma_f32_16x16x32_bf16 a[240:243], v[160:163], v[184:187], a[240:243]
    ds_read2_b32 v[94:95], v10 offset0:18 offset1:19
    v_mfma_f32_16x16x32_bf16 a[244:247], v[164:167], v[184:187], a[244:247]
    ds_read2_b32 v[96:97], v11 offset0:144 offset1:145
    v_mfma_f32_16x16x32_bf16 a[248:251], v[168:171], v[184:187], a[248:251]
    ds_read2_b32 v[98:99], v11 offset0:146 offset1:147
    s_add_u32 m0, s15, 4096
    s_nop 0
    buffer_load_dwordx4 v65, s[52:55], s91 offen lds
    v_mfma_f32_16x16x32_bf16 a[252:255], v[172:175], v[184:187], a[252:255]
    ds_read2_b32 v[100:101], v11 offset0:16 offset1:17
    s_waitcnt lgkmcnt(15)
    v_mfma_f32_16x16x32_bf16 a[232:235], v[148:151], v[188:191], a[232:235]
    ds_read2_b32 v[102:103], v11 offset0:18 offset1:19
    v_mfma_f32_16x16x32_bf16 a[236:239], v[152:155], v[188:191], a[236:239]
    ds_read_b128 v[104:107], v15 offset:64
    v_mfma_f32_16x16x32_bf16 a[240:243], v[156:159], v[188:191], a[240:243]
    ds_read_b128 v[108:111], v15 offset:576
    v_mfma_f32_16x16x32_bf16 a[244:247], v[160:163], v[188:191], a[244:247]
    ds_read_b128 v[112:115], v15 offset:1088
    v_mfma_f32_16x16x32_bf16 a[248:251], v[164:167], v[188:191], a[248:251]
    ds_read_b128 v[116:119], v15 offset:1600
    v_mfma_f32_16x16x32_bf16 a[252:255], v[168:171], v[188:191], a[252:255]
    ds_read_b128 v[120:123], v15 offset:2112
    s_add_u32 m0, s15, 8192
    s_nop 0
    buffer_load_dwordx4 v66, s[52:55], s91 offen lds
    v_mfma_f32_16x16x32_bf16 a[236:239], v[148:151], v[192:195], a[236:239]
    ds_read_b128 v[124:127], v15 offset:2624
    v_mfma_f32_16x16x32_bf16 a[240:243], v[152:155], v[192:195], a[240:243]
    ds_read_b128 v[128:131], v15 offset:3136
    v_mfma_f32_16x16x32_bf16 a[244:247], v[156:159], v[192:195], a[244:247]
    ds_read_b128 v[132:135], v15 offset:3648
    v_mfma_f32_16x16x32_bf16 a[248:251], v[160:163], v[192:195], a[248:251]
    v_cvt_pk_bf16_f32 v50, v50, v51
    v_bfe_u32 v138, v0, 5, 1
    v_mfma_f32_16x16x32_bf16 a[252:255], v[164:167], v[192:195], a[252:255]
    v_mov_b32 v137, v136
    v_lshl_add_u32 v32, v138, 1, v32
    v_mfma_f32_16x16x32_bf16 a[240:243], v[148:151], v[196:199], a[240:243]
    v_permlane16_swap_b32 v136, v137
    v_add_f32 v136, v136, v137
    v_mfma_f32_16x16x32_bf16 a[244:247], v[152:155], v[196:199], a[244:247]
    v_cvt_pk_bf16_f32 v136, v136, v136
    v_lshlrev_b32 v136, 16, v136
    s_add_u32 m0, s15, 12288
    s_nop 0
    buffer_load_dwordx4 v67, s[52:55], s91 offen lds
    v_mfma_f32_16x16x32_bf16 a[248:251], v[156:159], v[196:199], a[248:251]
    v_add_f32 v136, v136, v34
    v_cvt_pk_bf16_f32 v136, v136, v136
    v_mfma_f32_16x16x32_bf16 a[252:255], v[160:163], v[196:199], a[252:255]
    ds_write_b16 v32, v136
    s_mov_b64 exec, 1
    buffer_store_dword v50, off, s[48:51], s86 sc1
    s_mov_b64 exec, -1
    v_mfma_f32_16x16x32_bf16 a[244:247], v[148:151], v[200:203], a[244:247]
    v_lshl_add_u32 v32, v2, 2, v3
    v_bfe_u32 v33, v0, 1, 2
    v_mfma_f32_16x16x32_bf16 a[248:251], v[152:155], v[200:203], a[248:251]
    v_xor_b32 v32, v32, v33
    s_lshl_b32 s8, s5, 13
    s_add_u32 s8, s8, 114688
    v_lshl_add_u32 v32, v32, 4, s8
    v_mfma_f32_16x16x32_bf16 a[252:255], v[156:159], v[200:203], a[252:255]
    v_bfe_u32 v33, v0, 3, 2
    v_xor_b32 v33, v33, v1
    v_mfma_f32_16x16x32_bf16 a[248:251], v[148:151], v[204:207], a[248:251]
    s_lshl_b32 s8, s5, 11
    s_add_u32 s8, s8, 114688
    v_lshl_add_u32 v33, v33, 4, s8
    v_lshrrev_b32 v4, 2, v1
    v_mfma_f32_16x16x32_bf16 a[252:255], v[152:155], v[204:207], a[252:255]
    v_mul_u32_u24 v4, 112, v4
    v_and_b32 v63, 3, v0
    s_add_u32 m0, s15, 16384
    s_nop 0
    buffer_load_dwordx4 v68, s[52:55], s91 offen lds
    v_mfma_f32_16x16x32_bf16 a[252:255], v[148:151], v[208:211], a[252:255]
    v_lshl_add_u32 v17, v63, 3, v4
    v_add_u32 v20, 57344, v17
    s_waitcnt lgkmcnt(8)
    v_mfma_f32_16x16x32_bf16 a[224:227], v[72:75], v[104:107], a[224:227]
    ds_read2_b32 v[148:149], v8 offset0:128 offset1:129
    v_mfma_f32_16x16x32_bf16 a[228:231], v[76:79], v[104:107], a[228:231]
    ds_read2_b32 v[150:151], v8 offset0:130 offset1:131
    v_mfma_f32_16x16x32_bf16 a[232:235], v[80:83], v[104:107], a[232:235]
    ds_read2_b32 v[152:153], v8 offset0:0 offset1:1
    v_mfma_f32_16x16x32_bf16 a[236:239], v[84:87], v[104:107], a[236:239]
    ds_read2_b32 v[154:155], v8 offset0:2 offset1:3
    v_mfma_f32_16x16x32_bf16 a[240:243], v[88:91], v[104:107], a[240:243]
    ds_read2_b32 v[156:157], v9 offset0:128 offset1:129
    v_mfma_f32_16x16x32_bf16 a[244:247], v[92:95], v[104:107], a[244:247]
    ds_read2_b32 v[158:159], v9 offset0:130 offset1:131
    s_add_u32 m0, s15, 20480
    s_nop 0
    buffer_load_dwordx4 v69, s[52:55], s91 offen lds
    v_mfma_f32_16x16x32_bf16 a[248:251], v[96:99], v[104:107], a[248:251]
    ds_read2_b32 v[160:161], v9 offset0:0 offset1:1
    v_mfma_f32_16x16x32_bf16 a[252:255], v[100:103], v[104:107], a[252:255]
    ds_read2_b32 v[162:163], v9 offset0:2 offset1:3
    s_waitcnt lgkmcnt(15)
    v_mfma_f32_16x16x32_bf16 a[228:231], v[72:75], v[108:111], a[228:231]
    ds_read2_b32 v[164:165], v10 offset0:128 offset1:129
    v_mfma_f32_16x16x32_bf16 a[232:235], v[76:79], v[108:111], a[232:235]
    ds_read2_b32 v[166:167], v10 offset0:130 offset1:131
    v_mfma_f32_16x16x32_bf16 a[236:239], v[80:83], v[108:111], a[236:239]
    ds_read2_b32 v[168:169], v10 offset0:0 offset1:1
    v_mfma_f32_16x16x32_bf16 a[240:243], v[84:87], v[108:111], a[240:243]
    ds_read2_b32 v[170:171], v10 offset0:2 offset1:3
    v_mfma_f32_16x16x32_bf16 a[244:247], v[88:91], v[108:111], a[244:247]
    ds_read2_b32 v[172:173], v11 offset0:128 offset1:129
    s_add_u32 m0, s15, 24576
    s_nop 0
    buffer_load_dwordx4 v70, s[52:55], s91 offen lds
    v_mfma_f32_16x16x32_bf16 a[248:251], v[92:95], v[108:111], a[248:251]
    ds_read2_b32 v[174:175], v11 offset0:130 offset1:131
    v_mfma_f32_16x16x32_bf16 a[252:255], v[96:99], v[108:111], a[252:255]
    ds_read2_b32 v[176:177], v11 offset0:0 offset1:1
    s_waitcnt lgkmcnt(15)
    v_mfma_f32_16x16x32_bf16 a[232:235], v[72:75], v[112:115], a[232:235]
    ds_read2_b32 v[178:179], v11 offset0:2 offset1:3
    v_mfma_f32_16x16x32_bf16 a[236:239], v[76:79], v[112:115], a[236:239]
    ds_read_b128 v[180:183], v15 offset:0
    v_mfma_f32_16x16x32_bf16 a[240:243], v[80:83], v[112:115], a[240:243]
    ds_read_b128 v[184:187], v15 offset:512
    v_mfma_f32_16x16x32_bf16 a[244:247], v[84:87], v[112:115], a[244:247]
    ds_read_b128 v[188:191], v15 offset:1024
    v_mfma_f32_16x16x32_bf16 a[248:251], v[88:91], v[112:115], a[248:251]
    ds_read_b128 v[192:195], v15 offset:1536
    s_add_u32 m0, s15, 57344
    s_nop 0
    buffer_load_dwordx4 v64, s[56:59], s91 offen lds
    v_mfma_f32_16x16x32_bf16 a[252:255], v[92:95], v[112:115], a[252:255]
    ds_read_b128 v[196:199], v15 offset:2048
    v_mfma_f32_16x16x32_bf16 a[236:239], v[72:75], v[116:119], a[236:239]
    ds_read_b128 v[200:203], v15 offset:2560
    v_mfma_f32_16x16x32_bf16 a[240:243], v[76:79], v[116:119], a[240:243]
    ds_read_b128 v[204:207], v15 offset:3072
    v_mfma_f32_16x16x32_bf16 a[244:247], v[80:83], v[116:119], a[244:247]
    ds_read_b128 v[208:211], v15 offset:3584
    v_mfma_f32_16x16x32_bf16 a[248:251], v[84:87], v[116:119], a[248:251]
    v_and_b32 v63, 1, v0
    v_lshl_add_u32 v4, v63, 3, v4
    v_mfma_f32_16x16x32_bf16 a[252:255], v[88:91], v[116:119], a[252:255]
    v_bfe_u32 v5, v0, 1, 1
    v_mul_u32_u24 v5, 57344, v5
    v_mfma_f32_16x16x32_bf16 a[240:243], v[72:75], v[120:123], a[240:243]
    v_add_u32 v4, 96, v4
    v_add_u32 v21, v4, v5
    s_add_u32 m0, s15, 61440
    s_nop 0
    buffer_load_dwordx4 v65, s[56:59], s91 offen lds
    v_mfma_f32_16x16x32_bf16 a[244:247], v[76:79], v[120:123], a[244:247]
    s_lshl_b32 s8, s5, 5
    s_cmp_lt_u32 s5, 3
    s_cselect_b32 s9, s8, 57344
    s_mul_i32 s10, s77, 7168
    s_add_u32 s9, s9, s10
    v_add_u32 v5, s9, v17
    s_lshl_b32 s8, s5, 5
    s_add_u32 s8, s8, 32
    v_add_u32 v12, s8, v20
    v_mfma_f32_16x16x32_bf16 a[248:251], v[80:83], v[120:123], a[248:251]
    s_cmp_lt_u32 s5, 2
    s_cselect_b64 s[10:11], -1, 0
    v_cndmask_b32 v12, v21, v12, s[10:11]
    s_mul_i32 s8, s77, 7168
    v_add_u32 v12, s8, v12
    v_mfma_f32_16x16x32_bf16 a[252:255], v[84:87], v[120:123], a[252:255]
    v_lshlrev_b32 v16, 7, v63
    v_lshl_add_u32 v16, v3, 3, v16
    v_mfma_f32_16x16x32_bf16 a[244:247], v[72:75], v[124:127], a[244:247]
    v_add_u32 v16, 147456, v16
    v_mul_u32_u24 v23, 448, v63
    v_mfma_f32_16x16x32_bf16 a[248:251], v[76:79], v[124:127], a[248:251]
    v_lshl_add_u32 v23, v3, 4, v23
    s_lshl_b32 s8, s5, 6
    s_add_u32 s8, s8, 256
    s_min_u32 s8, s8, 384
    v_add_u32 v58, s8, v23
    v_mfma_f32_16x16x32_bf16 a[252:255], v[80:83], v[124:127], a[252:255]
    s_lshl_b32 s8, s5, 6
    v_add_u32 v23, s8, v23
    v_mov_b32 v42, 0xbf317218
    v_mfma_f32_16x16x32_bf16 a[248:251], v[72:75], v[128:131], a[248:251]
    v_mov_b32 v4, 0xbfb8aa3b
    v_cmp_gt_u32 vcc, 2, v3
    s_cmp_lt_u32 s5, 2
    s_cselect_b64 vcc, 0, vcc
    v_cndmask_b32 v42, v42, v4, vcc
    s_add_u32 m0, s15, 65536
    s_nop 0
    buffer_load_dwordx4 v66, s[56:59], s91 offen lds
    v_mfma_f32_16x16x32_bf16 a[252:255], v[76:79], v[128:131], a[252:255]
    s_mov_b32 s8, 0xbf317218
    s_cmp_lt_u32 s5, 3
    s_cselect_b32 s8, 0xbfb8aa3b, s8
    v_mov_b32 v40, s8
    v_cmp_eq_u32 vcc, 1, v63
    s_nop 1
    v_cndmask_b32 v42, 1.0, v42, vcc
    v_cndmask_b32 v40, 1.0, v40, vcc
    v_mfma_f32_16x16x32_bf16 a[252:255], v[72:75], v[132:135], a[252:255]
    v_fma_f32 v212, v236, v54, v212
    v_fma_f32 v213, v237, v54, v213
    s_waitcnt lgkmcnt(7)
    v_mfma_f32_16x16x32_bf16 a[224:227], v[148:151], v[180:183], a[224:227]
    v_fma_f32 v214, v238, v54, v214
    v_fma_f32 v215, v239, v54, v215
    v_mfma_f32_16x16x32_bf16 a[228:231], v[152:155], v[180:183], a[228:231]
    v_fma_f32 v216, v240, v55, v216
    v_fma_f32 v217, v241, v55, v217
    v_mfma_f32_16x16x32_bf16 a[232:235], v[156:159], v[180:183], a[232:235]
    s_waitcnt vmcnt(11)
    s_waitcnt lgkmcnt(0)
    s_barrier
    v_fma_f32 v218, v242, v55, v218
    v_fma_f32 v219, v243, v55, v219
    v_mfma_f32_16x16x32_bf16 a[236:239], v[160:163], v[180:183], a[236:239]
    v_fma_f32 v220, v244, v54, v220
    v_fma_f32 v221, v245, v54, v221
    v_mfma_f32_16x16x32_bf16 a[240:243], v[164:167], v[180:183], a[240:243]
    ds_read2_b64 v[72:75], v16 offset0:0 offset1:4
    v_fma_f32 v222, v246, v54, v222
    s_add_u32 m0, s15, 69632
    s_nop 0
    buffer_load_dwordx4 v67, s[56:59], s91 offen lds
    v_mfma_f32_16x16x32_bf16 a[244:247], v[168:171], v[180:183], a[244:247]
    ds_read_b64_tr_b16 v[76:77], v5 offset:0
    v_fma_f32 v223, v247, v54, v223
    v_mfma_f32_16x16x32_bf16 a[248:251], v[172:175], v[180:183], a[248:251]
    ds_read_b64_tr_b16 v[78:79], v5 offset:1792
    v_fma_f32 v224, v248, v55, v224
    v_mfma_f32_16x16x32_bf16 a[252:255], v[176:179], v[180:183], a[252:255]
    ds_write_b128 v32, a[224:227] offset:0
    v_fma_f32 v225, v249, v55, v225
    v_mfma_f32_16x16x32_bf16 a[228:231], v[148:151], v[184:187], a[228:231]
    ds_read_b64_tr_b16 v[80:81], v12 offset:0
    v_fma_f32 v226, v250, v55, v226
    v_mfma_f32_16x16x32_bf16 a[232:235], v[152:155], v[184:187], a[232:235]
    ds_read_b64_tr_b16 v[82:83], v12 offset:1792
    v_fma_f32 v227, v251, v55, v227
    v_mfma_f32_16x16x32_bf16 a[236:239], v[156:159], v[184:187], a[236:239]
    ds_read2_b64 v[84:87], v16 offset0:8 offset1:12
    v_mfma_f32_16x16x32_bf16 a[240:243], v[160:163], v[184:187], a[240:243]
    ds_read_b64_tr_b16 v[88:89], v5 offset:3584
    s_add_u32 m0, s15, 73728
    s_nop 0
    buffer_load_dwordx4 v68, s[56:59], s91 offen lds
    v_mfma_f32_16x16x32_bf16 a[244:247], v[164:167], v[184:187], a[244:247]
    ds_read_b64_tr_b16 v[90:91], v5 offset:5376
    v_mfma_f32_16x16x32_bf16 a[248:251], v[168:171], v[184:187], a[248:251]
    ds_read_b64_tr_b16 v[92:93], v12 offset:3584
    v_mfma_f32_16x16x32_bf16 a[252:255], v[172:175], v[184:187], a[252:255]
    ds_read_b64_tr_b16 v[94:95], v12 offset:5376
    v_mfma_f32_16x16x32_bf16 a[232:235], v[148:151], v[188:191], a[232:235]
    ds_write_b128 v32, a[228:231] offset:1024
    v_mfma_f32_16x16x32_bf16 a[236:239], v[152:155], v[188:191], a[236:239]
    v_mfma_f32_16x16x32_bf16 a[240:243], v[156:159], v[188:191], a[240:243]
    v_mfma_f32_16x16x32_bf16 a[244:247], v[160:163], v[188:191], a[244:247]
    s_waitcnt lgkmcnt(9)
    v_mfma_f32_16x16x32_bf16 v[128:131], v[76:79], v[72:75], 0
    s_add_u32 m0, s15, 77824
    s_nop 0
    buffer_load_dwordx4 v69, s[56:59], s91 offen lds
    v_mfma_f32_16x16x32_bf16 a[248:251], v[164:167], v[188:191], a[248:251]
    s_waitcnt lgkmcnt(6)
    v_mfma_f32_16x16x32_bf16 v[132:135], v[80:83], v[72:75], 0
    v_mfma_f32_16x16x32_bf16 a[252:255], v[168:171], v[188:191], a[252:255]
    s_waitcnt lgkmcnt(3)
    v_mfma_f32_16x16x32_bf16 v[128:131], v[88:91], v[84:87], v[128:131]
    v_mfma_f32_16x16x32_bf16 a[236:239], v[148:151], v[192:195], a[236:239]
    s_waitcnt lgkmcnt(1)
    v_mfma_f32_16x16x32_bf16 v[132:135], v[92:95], v[84:87], v[132:135]
    v_mfma_f32_16x16x32_bf16 a[240:243], v[152:155], v[192:195], a[240:243]
    ds_write_b128 v32, a[232:235] offset:2048
    v_mfma_f32_16x16x32_bf16 a[244:247], v[156:159], v[192:195], a[244:247]
    v_mfma_f32_16x16x32_bf16 a[248:251], v[160:163], v[192:195], a[248:251]
    s_nop 0
    v_mul_f32 v128, v128, v40
    v_mul_f32 v129, v129, v40
    v_mfma_f32_16x16x32_bf16 a[252:255], v[164:167], v[192:195], a[252:255]
    v_mul_f32 v130, v130, v40
    v_mul_f32 v131, v131, v40
    s_add_u32 m0, s15, 81920
    s_nop 0
    buffer_load_dwordx4 v70, s[56:59], s91 offen lds
    v_mfma_f32_16x16x32_bf16 a[240:243], v[148:151], v[196:199], a[240:243]
    v_mul_f32 v132, v132, v42
    v_mul_f32 v133, v133, v42
    v_mfma_f32_16x16x32_bf16 a[244:247], v[152:155], v[196:199], a[244:247]
    v_mul_f32 v134, v134, v42
    v_mul_f32 v135, v135, v42
    v_mfma_f32_16x16x32_bf16 a[248:251], v[156:159], v[196:199], a[248:251]
    ds_write_b128 v32, a[236:239] offset:3072
    s_mov_b32 exec_lo, 0x00030003
    s_mov_b32 exec_hi, 0x00030003
    buffer_store_dwordx4 v[128:131], v23, s[48:51], s95 offen sc1
    buffer_store_dwordx4 v[132:135], v58, s[48:51], s95 offen sc1
    s_mov_b64 exec, -1
    v_mfma_f32_16x16x32_bf16 a[252:255], v[160:163], v[196:199], a[252:255]
    v_mfma_f32_16x16x32_bf16 a[244:247], v[148:151], v[200:203], a[244:247]
    v_mfma_f32_16x16x32_bf16 a[248:251], v[152:155], v[200:203], a[248:251]
    v_mfma_f32_16x16x32_bf16 a[252:255], v[156:159], v[200:203], a[252:255]
    v_mfma_f32_16x16x32_bf16 a[248:251], v[148:151], v[204:207], a[248:251]
    ds_write_b128 v32, a[240:243] offset:4096
    v_mfma_f32_16x16x32_bf16 a[252:255], v[152:155], v[204:207], a[252:255]
    v_mfma_f32_16x16x32_bf16 a[252:255], v[148:151], v[208:211], a[252:255]
    s_nop 1
    ds_write_b128 v32, a[244:247] offset:5120
    s_nop 1
    ds_write_b128 v32, a[248:251] offset:6144
    s_nop 1
    ds_write_b128 v32, a[252:255] offset:7168
    s_waitcnt lgkmcnt(0)
    s_barrier
    ds_read_b128 v[72:75], v33 offset:0
    ds_read_b128 v[76:79], v33 offset:8192
    ds_read_b128 v[80:83], v33 offset:16384
    ds_read_b128 v[84:87], v33 offset:24576
    ds_read_b128 v[88:91], v33 offset:1024
    ds_read_b128 v[92:95], v33 offset:9216
    ds_read_b128 v[96:99], v33 offset:17408
    ds_read_b128 v[100:103], v33 offset:25600
    s_waitcnt lgkmcnt(6)
    v_pk_add_f32 v[72:73], v[72:73], v[76:77]
    v_pk_add_f32 v[74:75], v[74:75], v[78:79]
    v_pk_fma_f32 v[212:213], v[72:73], s[44:45], v[212:213] op_sel:[0,0,0] op_sel_hi:[1,0,1]
    v_pk_fma_f32 v[214:215], v[74:75], s[44:45], v[214:215] op_sel:[0,0,0] op_sel_hi:[1,0,1]
    v_pk_mul_f32 v[236:237], v[212:213], s[46:47] op_sel:[0,0] op_sel_hi:[1,0]
    v_pk_mul_f32 v[238:239], v[214:215], s[46:47] op_sel:[0,0] op_sel_hi:[1,0]
    s_waitcnt lgkmcnt(4)
    v_pk_add_f32 v[80:81], v[80:81], v[84:85]
    v_pk_add_f32 v[82:83], v[82:83], v[86:87]
    v_pk_fma_f32 v[216:217], v[80:81], s[44:45], v[216:217] op_sel:[0,1,0] op_sel_hi:[1,1,1]
    v_pk_fma_f32 v[218:219], v[82:83], s[44:45], v[218:219] op_sel:[0,1,0] op_sel_hi:[1,1,1]
    v_pk_mul_f32 v[240:241], v[216:217], s[46:47] op_sel:[0,1] op_sel_hi:[1,1]
    v_pk_mul_f32 v[242:243], v[218:219], s[46:47] op_sel:[0,1] op_sel_hi:[1,1]
    v_cvt_pk_bf16_f32 v104, v236, v240
    v_cvt_pk_bf16_f32 v105, v237, v241
    v_cvt_pk_bf16_f32 v106, v238, v242
    v_cvt_pk_bf16_f32 v107, v239, v243
    buffer_store_dwordx4 v[104:107], v6, s[48:51], s84 offen offset:0 sc1
    s_waitcnt lgkmcnt(2)
    v_pk_add_f32 v[88:89], v[88:89], v[92:93]
    v_pk_add_f32 v[90:91], v[90:91], v[94:95]
    v_pk_fma_f32 v[220:221], v[88:89], s[44:45], v[220:221] op_sel:[0,0,0] op_sel_hi:[1,0,1]
    v_pk_fma_f32 v[222:223], v[90:91], s[44:45], v[222:223] op_sel:[0,0,0] op_sel_hi:[1,0,1]
    v_pk_mul_f32 v[244:245], v[220:221], s[46:47] op_sel:[0,0] op_sel_hi:[1,0]
    v_pk_mul_f32 v[246:247], v[222:223], s[46:47] op_sel:[0,0] op_sel_hi:[1,0]
    s_waitcnt lgkmcnt(0)
    v_pk_add_f32 v[96:97], v[96:97], v[100:101]
    v_pk_add_f32 v[98:99], v[98:99], v[102:103]
    v_pk_fma_f32 v[224:225], v[96:97], s[44:45], v[224:225] op_sel:[0,1,0] op_sel_hi:[1,1,1]
    v_pk_fma_f32 v[226:227], v[98:99], s[44:45], v[226:227] op_sel:[0,1,0] op_sel_hi:[1,1,1]
    v_pk_mul_f32 v[248:249], v[224:225], s[46:47] op_sel:[0,1] op_sel_hi:[1,1]
    v_pk_mul_f32 v[250:251], v[226:227], s[46:47] op_sel:[0,1] op_sel_hi:[1,1]
    v_cvt_pk_bf16_f32 v112, v244, v248
    v_cvt_pk_bf16_f32 v113, v245, v249
    v_cvt_pk_bf16_f32 v114, v246, v250
    v_cvt_pk_bf16_f32 v115, v247, v251
    buffer_store_dwordx4 v[112:115], v6, s[48:51], s84 offen offset:1024 sc1
    v_cvt_pk_bf16_f32 v66, v212, v216
    v_cvt_pk_bf16_f32 v67, v213, v217
    v_cvt_pk_bf16_f32 v68, v214, v218
    v_cvt_pk_bf16_f32 v69, v215, v219
    v_cvt_pk_bf16_f32 v70, v220, v224
    v_cvt_pk_bf16_f32 v71, v221, v225
    v_cvt_pk_bf16_f32 v72, v222, v226
    v_cvt_pk_bf16_f32 v73, v223, v227
    s_mov_b32 s12, s83
    v_mul_u32_u24 v4, 16896, v3
    v_lshl_add_u32 v8, v2, 4, v4
    v_add_u32 v9, 8448, v8
    v_add_u32 v10, 67584, v8
    v_add_u32 v11, 76032, v8
    v_lshrrev_b32 v4, 1, v0
    v_mul_u32_u24 v5, 8448, v4
    v_and_b32 v4, 1, v0
    v_lshl_add_u32 v5, v4, 4, v5
    s_lshl_b32 s8, s77, 10
    s_lshl_b32 s9, s5, 8
    s_add_u32 s8, s8, s9
    s_add_u32 s80, s8, 4718592
    s_add_u32 s81, s8, 19070976
    s_add_u32 s82, s88, 4278255616
    s_add_u32 s83, s82, 1081344
    s_lshl_b32 s8, s5, 6
    s_add_u32 s8, s8, 1024
    v_lshl_add_u32 v24, v4, 5, s8
    v_bfe_u32 v4, v0, 4, 1
    v_lshl_add_u32 v24, v4, 4, v24
    v_bfe_u32 v4, v0, 5, 1
    v_lshl_add_u32 v24, v4, 3, v24
    v_and_b32 v4, 7, v0
    s_mov_b32 s8, 1024
    v_lshl_add_u32 v25, v4, 3, s8
    s_lshl_b32 s8, s77, 2
    s_add_u32 s8, s8, s5
    s_mul_i32 s8, s8, 229376
    s_mul_i32 s9, s78, 1792
    s_add_u32 s8, s8, s9
    s_add_u32 s84, s8, 8388608
    s_cmp_eq_u32 s5, 0
    s_cselect_b32 s85, s88, 1073741824
    s_lshl_b32 s8, s78, 13
    s_add_u32 s86, s8, 19529728
    s_lshl_b32 s8, s5, 8
    s_add_u32 s86, s86, s8
    s_add_u32 s93, s86, 4096
    v_lshlrev_b32 v4, 10, v3
    v_lshl_add_u32 v12, v2, 4, v4
    s_lshr_b32 s8, s76, 4
    s_lshl_b32 s8, s8, 7
    s_and_b32 s9, s76, 15
    s_lshl_b32 s9, s9, 2
    s_add_u32 s8, s8, s9
    s_lshl_b32 s9, s5, 12
    s_add_u32 s8, s8, s9
    s_add_u32 s8, s8, 19136576
    v_lshrrev_b32 v4, 1, v2
    v_lshl_add_u32 v15, v4, 14, s8
    v_and_b32 v4, 1, v0
    v_lshl_add_u32 v15, v4, 11, v15
    s_and_b32 s8, s2, 63
    s_lshl_b32 s8, s8, 11
    s_lshl_b32 s9, s5, 8
    s_add_u32 s8, s8, s9
    s_add_u32 s8, s8, 19136576
    v_lshl_add_u32 v16, v2, 2, s8
    v_bfe_u32 v4, v0, 4, 1
    v_lshl_add_u32 v16, v4, 7, v16
    v_bfe_u32 v4, v0, 5, 1
    v_lshl_add_u32 v16, v4, 10, v16
    v_mov_b32 v26, v18
    v_mov_b32 v27, v18
    v_mov_b32 v28, v18
    v_mov_b32 v29, v18
    s_lshl_b32 s8, s76, 6
    s_lshl_b32 s9, s5, 15
    s_add_u32 s8, s8, s9
    s_add_u32 s8, s8, 19791872
    v_bfe_u32 v4, v0, 2, 1
    v_lshl_add_u32 v15, v4, 14, s8
    v_and_b32 v4, 3, v0
    v_lshl_add_u32 v15, v4, 4, v15
    s_lshl_b32 s8, s3, 14
    s_lshl_b32 s9, s5, 11
    s_add_u32 s8, s8, s9
    s_add_u32 s8, s8, 19791872
    v_and_b32 v4, 31, v0
    v_lshl_add_u32 v16, v4, 6, s8
    v_bfe_u32 v4, v0, 5, 1
    v_lshl_add_u32 v16, v4, 13, v16
    s_waitcnt vmcnt(0)
    s_barrier
    s_mov_b32 s8, 19136512
    s_cmp_lt_u32 s5, 1
    s_cselect_b32 s8, s8, 1073741824
    buffer_store_dword v18, v61, s[48:51], s8 offen sc1
    buffer_store_dwordx4 v[66:69], v6, s[48:51], s12 offen offset:0 sc1
    buffer_store_dwordx4 v[70:73], v6, s[48:51], s12 offen offset:1024 sc1
    ds_read_b64_tr_b16 v[30:31], v17 offset:0
    ds_read_b64_tr_b16 v[32:33], v17 offset:1792
    ds_read_b64_tr_b16 v[34:35], v17 offset:32
    ds_read_b64_tr_b16 v[36:37], v17 offset:1824
    ds_read_b64_tr_b16 v[38:39], v17 offset:64
    ds_read_b64_tr_b16 v[40:41], v17 offset:1856
    ds_read_b64_tr_b16 v[42:43], v20 offset:0
    ds_read_b64_tr_b16 v[44:45], v20 offset:1792
    ds_read_b64_tr_b16 v[46:47], v20 offset:32
    ds_read_b64_tr_b16 v[48:49], v20 offset:1824
    ds_read_b64_tr_b16 v[50:51], v20 offset:64
    ds_read_b64_tr_b16 v[52:53], v20 offset:1856
    ds_read_b64_tr_b16 v[54:55], v21 offset:0
    ds_read_b64_tr_b16 v[56:57], v21 offset:1792
    s_mov_b32 s8, 98304
    s_mov_b32 s8, 19136512
    s_mov_b32 s6, 32768
L_apoll3:
    v_mov_b32 v19, 0
    buffer_atomic_add v19, v62, s[48:51], s8 offen sc0 sc1
    s_waitcnt vmcnt(0)
    v_cmp_ne_u32 vcc, v18, v19
    s_mov_b64 exec, vcc
    s_cbranch_vccz L_aend4
    s_sub_u32 s6, s6, 1
    s_cmp_lg_u32 s6, 0
    s_cbranch_scc1 L_apoll3
L_aend4:
    s_mov_b64 exec, -1
    s_mov_b64 exec, 0xff
    buffer_store_dwordx4 v[26:29], v15, s[48:51], 0 offen sc1
    s_mov_b64 exec, -1
    s_waitcnt lgkmcnt(0)
    s_barrier
    buffer_load_dwordx4 a[224:227], v8, s[48:51], s80 offen sc1
    buffer_load_dwordx4 a[228:231], v9, s[48:51], s80 offen sc1
    buffer_load_dwordx4 a[232:235], v10, s[48:51], s80 offen sc1
    buffer_load_dwordx4 a[236:239], v11, s[48:51], s80 offen sc1
    s_add_u32 s80, s80, 135168
    buffer_load_dwordx4 v[74:77], v8, s[48:51], s80 offen sc1
    buffer_load_dwordx4 v[78:81], v9, s[48:51], s80 offen sc1
    buffer_load_dwordx4 v[82:85], v10, s[48:51], s80 offen sc1
    buffer_load_dwordx4 v[86:89], v11, s[48:51], s80 offen sc1
    s_add_u32 s80, s80, 135168
    buffer_load_dwordx4 a[240:243], v8, s[48:51], s80 offen sc1
    buffer_load_dwordx4 a[244:247], v9, s[48:51], s80 offen sc1
    buffer_load_dwordx4 a[248:251], v10, s[48:51], s80 offen sc1
    buffer_load_dwordx4 a[252:255], v11, s[48:51], s80 offen sc1
    s_add_u32 s80, s80, 135168
    s_mov_b32 s9, 0x3f803f80
    s_waitcnt vmcnt(11)
    v_accvgpr_read_b32 v106, a224
    v_accvgpr_read_b32 v110, a225
    v_accvgpr_read_b32 v114, a226
    v_accvgpr_read_b32 v118, a227
    s_waitcnt vmcnt(10)
    v_accvgpr_read_b32 v107, a228
    v_accvgpr_read_b32 v111, a229
    v_accvgpr_read_b32 v115, a230
    v_accvgpr_read_b32 v119, a231
    s_waitcnt vmcnt(9)
    v_accvgpr_read_b32 v108, a232
    v_accvgpr_read_b32 v112, a233
    v_accvgpr_read_b32 v116, a234
    v_accvgpr_read_b32 v120, a235
    s_waitcnt vmcnt(8)
    v_accvgpr_read_b32 v109, a236
    v_accvgpr_read_b32 v113, a237
    v_accvgpr_read_b32 v117, a238
    v_accvgpr_read_b32 v121, a239
    v_mfma_f32_16x16x32_bf16 v[138:141], v[30:33], v[106:109], 0
    buffer_load_dwordx4 v[90:93], v8, s[48:51], s80 offen sc1
    v_mfma_f32_16x16x32_bf16 v[142:145], v[30:33], v[110:113], 0
    buffer_load_dwordx4 v[94:97], v9, s[48:51], s80 offen sc1
    v_mfma_f32_16x16x32_bf16 v[146:149], v[30:33], v[114:117], 0
    s_waitcnt vmcnt(9)
    v_mov_b32 v122, v74
    buffer_load_dwordx4 v[98:101], v10, s[48:51], s80 offen sc1
    v_mfma_f32_16x16x32_bf16 v[150:153], v[30:33], v[118:121], 0
    v_mov_b32 v126, v75
    buffer_load_dwordx4 v[102:105], v11, s[48:51], s80 offen sc1
    s_add_u32 s80, s80, 135168
    v_mfma_f32_16x16x32_bf16 v[154:157], v[34:37], v[106:109], 0
    ds_read_b64_tr_b16 v[30:31], v17 offset:3584
    v_mov_b32 v130, v76
    v_mfma_f32_16x16x32_bf16 v[158:161], v[34:37], v[110:113], 0
    ds_read_b64_tr_b16 v[32:33], v17 offset:5376
    v_mov_b32 v134, v77
    v_mfma_f32_16x16x32_bf16 v[162:165], v[34:37], v[114:117], 0
    s_waitcnt vmcnt(10)
    v_mov_b32 v123, v78
    buffer_load_dwordx4 a[224:227], v8, s[48:51], s80 offen sc1
    v_mfma_f32_16x16x32_bf16 v[166:169], v[34:37], v[118:121], 0
    v_mov_b32 v127, v79
    buffer_load_dwordx4 a[228:231], v9, s[48:51], s80 offen sc1
    v_mfma_f32_16x16x32_bf16 v[170:173], v[38:41], v[106:109], 0
    ds_read_b64_tr_b16 v[34:35], v17 offset:3616
    v_mov_b32 v131, v80
    v_mfma_f32_16x16x32_bf16 v[174:177], v[38:41], v[110:113], 0
    ds_read_b64_tr_b16 v[36:37], v17 offset:5408
    v_mov_b32 v135, v81
    v_mfma_f32_16x16x32_bf16 v[178:181], v[38:41], v[114:117], 0
    s_waitcnt vmcnt(11)
    v_mov_b32 v124, v82
    buffer_load_dwordx4 a[232:235], v10, s[48:51], s80 offen sc1
    v_mfma_f32_16x16x32_bf16 v[182:185], v[38:41], v[118:121], 0
    v_mov_b32 v128, v83
    buffer_load_dwordx4 a[236:239], v11, s[48:51], s80 offen sc1
    s_add_u32 s80, s80, 135168
    v_mfma_f32_16x16x32_bf16 v[186:189], v[42:45], v[106:109], 0
    ds_read_b64_tr_b16 v[38:39], v17 offset:3648
    v_mov_b32 v132, v84
    v_mfma_f32_16x16x32_bf16 v[190:193], v[42:45], v[110:113], 0
    ds_read_b64_tr_b16 v[40:41], v17 offset:5440
    v_mov_b32 v136, v85
    v_mfma_f32_16x16x32_bf16 v[194:197], v[42:45], v[114:117], 0
    s_waitcnt vmcnt(12)
    v_mov_b32 v125, v86
    v_mfma_f32_16x16x32_bf16 v[198:201], v[42:45], v[118:121], 0
    v_mov_b32 v129, v87
    v_mfma_f32_16x16x32_bf16 v[202:205], v[46:49], v[106:109], 0
    ds_read_b64_tr_b16 v[42:43], v20 offset:3584
    v_mov_b32 v133, v88
    v_mfma_f32_16x16x32_bf16 v[206:209], v[46:49], v[110:113], 0
    ds_read_b64_tr_b16 v[44:45], v20 offset:5376
    v_mov_b32 v137, v89
    v_mfma_f32_16x16x32_bf16 v[210:213], v[46:49], v[114:117], 0
    buffer_load_dwordx4 v[74:77], v8, s[48:51], s80 offen sc1
    v_mfma_f32_16x16x32_bf16 v[214:217], v[46:49], v[118:121], 0
    buffer_load_dwordx4 v[78:81], v9, s[48:51], s80 offen sc1
    v_mfma_f32_16x16x32_bf16 v[218:221], v[50:53], v[106:109], 0
    ds_read_b64_tr_b16 v[46:47], v20 offset:3616
    buffer_load_dwordx4 v[82:85], v10, s[48:51], s80 offen sc1
    v_mfma_f32_16x16x32_bf16 v[222:225], v[50:53], v[110:113], 0
    ds_read_b64_tr_b16 v[48:49], v20 offset:5408
    buffer_load_dwordx4 v[86:89], v11, s[48:51], s80 offen sc1
    s_add_u32 s80, s80, 135168
    v_mfma_f32_16x16x32_bf16 v[226:229], v[50:53], v[114:117], 0
    v_mfma_f32_16x16x32_bf16 v[230:233], v[50:53], v[118:121], 0
    v_mfma_f32_16x16x32_bf16 v[234:237], v[54:57], v[106:109], 0
    ds_read_b64_tr_b16 v[50:51], v20 offset:3648
    v_mfma_f32_16x16x32_bf16 v[238:241], v[54:57], v[110:113], 0
    ds_read_b64_tr_b16 v[52:53], v20 offset:5440
    v_mfma_f32_16x16x32_bf16 v[242:245], v[54:57], v[114:117], 0
    v_mfma_f32_16x16x32_bf16 v[246:249], v[54:57], v[118:121], 0
    s_waitcnt lgkmcnt(4)
    v_mfma_f32_16x16x32_bf16 v[138:141], v[30:33], v[122:125], v[138:141]
    ds_read_b64_tr_b16 v[54:55], v21 offset:3584
    v_mfma_f32_16x16x32_bf16 v[142:145], v[30:33], v[126:129], v[142:145]
    ds_read_b64_tr_b16 v[56:57], v21 offset:5376
    v_mfma_f32_16x16x32_bf16 v[146:149], v[30:33], v[130:133], v[146:149]
    s_waitcnt vmcnt(15)
    v_accvgpr_read_b32 v106, a240
    v_accvgpr_read_b32 v110, a241
    v_mfma_f32_16x16x32_bf16 v[150:153], v[30:33], v[134:137], v[150:153]
    buffer_load_dword v58, v16, s[48:51], 0 offen sc1
    v_mfma_f32_16x16x32_bf16 v[154:157], v[34:37], v[122:125], v[154:157]
    ds_read_b64_tr_b16 v[30:31], v17 offset:7168
    v_accvgpr_read_b32 v114, a242
    v_mfma_f32_16x16x32_bf16 v[158:161], v[34:37], v[126:129], v[158:161]
    ds_read_b64_tr_b16 v[32:33], v17 offset:8960
    v_accvgpr_read_b32 v118, a243
    v_mfma_f32_16x16x32_bf16 v[162:165], v[34:37], v[130:133], v[162:165]
    s_waitcnt vmcnt(15)
    v_accvgpr_read_b32 v107, a244
    v_accvgpr_read_b32 v111, a245
    v_mfma_f32_16x16x32_bf16 v[166:169], v[34:37], v[134:137], v[166:169]
    buffer_load_dwordx4 a[240:243], v8, s[48:51], s80 offen sc1
    v_mfma_f32_16x16x32_bf16 v[170:173], v[38:41], v[122:125], v[170:173]
    ds_read_b64_tr_b16 v[34:35], v17 offset:7200
    v_accvgpr_read_b32 v115, a246
    v_mfma_f32_16x16x32_bf16 v[174:177], v[38:41], v[126:129], v[174:177]
    ds_read_b64_tr_b16 v[36:37], v17 offset:8992
    v_accvgpr_read_b32 v119, a247
    v_mfma_f32_16x16x32_bf16 v[178:181], v[38:41], v[130:133], v[178:181]
    s_waitcnt vmcnt(15)
    v_accvgpr_read_b32 v108, a248
    v_accvgpr_read_b32 v112, a249
    v_mfma_f32_16x16x32_bf16 v[182:185], v[38:41], v[134:137], v[182:185]
    buffer_load_dwordx4 a[244:247], v9, s[48:51], s80 offen sc1
    v_mfma_f32_16x16x32_bf16 v[186:189], v[42:45], v[122:125], v[186:189]
    ds_read_b64_tr_b16 v[38:39], v17 offset:7232
    v_accvgpr_read_b32 v116, a250
    v_mfma_f32_16x16x32_bf16 v[190:193], v[42:45], v[126:129], v[190:193]
    ds_read_b64_tr_b16 v[40:41], v17 offset:9024
    v_accvgpr_read_b32 v120, a251
    v_mfma_f32_16x16x32_bf16 v[194:197], v[42:45], v[130:133], v[194:197]
    s_waitcnt vmcnt(15)
    v_accvgpr_read_b32 v109, a252
    v_accvgpr_read_b32 v113, a253
    v_mfma_f32_16x16x32_bf16 v[198:201], v[42:45], v[134:137], v[198:201]
    buffer_load_dwordx4 a[248:251], v10, s[48:51], s80 offen sc1
    s_waitcnt lgkmcnt(6)
    v_mfma_f32_16x16x32_bf16 v[202:205], v[46:49], v[122:125], v[202:205]
    ds_read_b64_tr_b16 v[42:43], v20 offset:7168
    v_accvgpr_read_b32 v117, a254
    v_mfma_f32_16x16x32_bf16 v[206:209], v[46:49], v[126:129], v[206:209]
    ds_read_b64_tr_b16 v[44:45], v20 offset:8960
    v_accvgpr_read_b32 v121, a255
    v_mfma_f32_16x16x32_bf16 v[210:213], v[46:49], v[130:133], v[210:213]
    v_mfma_f32_16x16x32_bf16 v[214:217], v[46:49], v[134:137], v[214:217]
    buffer_load_dwordx4 a[252:255], v11, s[48:51], s80 offen sc1
    s_add_u32 s80, s80, 135168
    v_mfma_f32_16x16x32_bf16 v[218:221], v[50:53], v[122:125], v[218:221]
    ds_read_b64_tr_b16 v[46:47], v20 offset:7200
    v_mfma_f32_16x16x32_bf16 v[222:225], v[50:53], v[126:129], v[222:225]
    ds_read_b64_tr_b16 v[48:49], v20 offset:8992
    v_mfma_f32_16x16x32_bf16 v[226:229], v[50:53], v[130:133], v[226:229]
    v_mfma_f32_16x16x32_bf16 v[230:233], v[50:53], v[134:137], v[230:233]
    v_mfma_f32_16x16x32_bf16 v[234:237], v[54:57], v[122:125], v[234:237]
    ds_read_b64_tr_b16 v[50:51], v20 offset:7232
    v_mfma_f32_16x16x32_bf16 v[238:241], v[54:57], v[126:129], v[238:241]
    ds_read_b64_tr_b16 v[52:53], v20 offset:9024
    v_mfma_f32_16x16x32_bf16 v[242:245], v[54:57], v[130:133], v[242:245]
    v_mfma_f32_16x16x32_bf16 v[246:249], v[54:57], v[134:137], v[246:249]
    s_waitcnt lgkmcnt(4)
    v_mfma_f32_16x16x32_bf16 v[138:141], v[30:33], v[106:109], v[138:141]
    ds_read_b64_tr_b16 v[54:55], v21 offset:7168
    v_mfma_f32_16x16x32_bf16 v[142:145], v[30:33], v[110:113], v[142:145]
    ds_read_b64_tr_b16 v[56:57], v21 offset:8960
    v_mfma_f32_16x16x32_bf16 v[146:149], v[30:33], v[114:117], v[146:149]
    s_waitcnt vmcnt(13)
    v_mov_b32 v122, v90
    v_mov_b32 v126, v91
    v_mfma_f32_16x16x32_bf16 v[150:153], v[30:33], v[118:121], v[150:153]
    v_mfma_f32_16x16x32_bf16 v[154:157], v[34:37], v[106:109], v[154:157]
    ds_read_b64_tr_b16 v[30:31], v17 offset:10752
    v_mov_b32 v130, v92
    v_mfma_f32_16x16x32_bf16 v[158:161], v[34:37], v[110:113], v[158:161]
    ds_read_b64_tr_b16 v[32:33], v17 offset:12544
    v_mov_b32 v134, v93
    v_mfma_f32_16x16x32_bf16 v[162:165], v[34:37], v[114:117], v[162:165]
    v_mov_b32 v123, v94
    v_mov_b32 v127, v95
    v_mfma_f32_16x16x32_bf16 v[166:169], v[34:37], v[118:121], v[166:169]
    buffer_load_dwordx4 v[90:93], v8, s[48:51], s80 offen sc1
    v_mfma_f32_16x16x32_bf16 v[170:173], v[38:41], v[106:109], v[170:173]
    ds_read_b64_tr_b16 v[34:35], v17 offset:10784
    v_mov_b32 v131, v96
    v_mfma_f32_16x16x32_bf16 v[174:177], v[38:41], v[110:113], v[174:177]
    ds_read_b64_tr_b16 v[36:37], v17 offset:12576
    v_mov_b32 v135, v97
    v_mfma_f32_16x16x32_bf16 v[178:181], v[38:41], v[114:117], v[178:181]
    v_mov_b32 v124, v98
    v_mov_b32 v128, v99
    v_mfma_f32_16x16x32_bf16 v[182:185], v[38:41], v[118:121], v[182:185]
    buffer_load_dwordx4 v[94:97], v9, s[48:51], s80 offen sc1
    v_mfma_f32_16x16x32_bf16 v[186:189], v[42:45], v[106:109], v[186:189]
    ds_read_b64_tr_b16 v[38:39], v17 offset:10816
    v_mov_b32 v132, v100
    v_mfma_f32_16x16x32_bf16 v[190:193], v[42:45], v[110:113], v[190:193]
    ds_read_b64_tr_b16 v[40:41], v17 offset:12608
    v_mov_b32 v136, v101
    v_mfma_f32_16x16x32_bf16 v[194:197], v[42:45], v[114:117], v[194:197]
    v_mov_b32 v125, v102
    v_mov_b32 v129, v103
    v_mfma_f32_16x16x32_bf16 v[198:201], v[42:45], v[118:121], v[198:201]
    buffer_load_dwordx4 v[98:101], v10, s[48:51], s80 offen sc1
    s_waitcnt lgkmcnt(6)
    v_mfma_f32_16x16x32_bf16 v[202:205], v[46:49], v[106:109], v[202:205]
    ds_read_b64_tr_b16 v[42:43], v20 offset:10752
    v_mov_b32 v133, v104
    v_mfma_f32_16x16x32_bf16 v[206:209], v[46:49], v[110:113], v[206:209]
    ds_read_b64_tr_b16 v[44:45], v20 offset:12544
    v_mov_b32 v137, v105
    v_mfma_f32_16x16x32_bf16 v[210:213], v[46:49], v[114:117], v[210:213]
    v_mfma_f32_16x16x32_bf16 v[214:217], v[46:49], v[118:121], v[214:217]
    buffer_load_dwordx4 v[102:105], v11, s[48:51], s80 offen sc1
    s_add_u32 s80, s80, 135168
    v_mfma_f32_16x16x32_bf16 v[218:221], v[50:53], v[106:109], v[218:221]
    ds_read_b64_tr_b16 v[46:47], v20 offset:10784
    v_mfma_f32_16x16x32_bf16 v[222:225], v[50:53], v[110:113], v[222:225]
    ds_read_b64_tr_b16 v[48:49], v20 offset:12576
    v_mfma_f32_16x16x32_bf16 v[226:229], v[50:53], v[114:117], v[226:229]
    v_mfma_f32_16x16x32_bf16 v[230:233], v[50:53], v[118:121], v[230:233]
    v_mfma_f32_16x16x32_bf16 v[234:237], v[54:57], v[106:109], v[234:237]
    ds_read_b64_tr_b16 v[50:51], v20 offset:10816
    v_mfma_f32_16x16x32_bf16 v[238:241], v[54:57], v[110:113], v[238:241]
    ds_read_b64_tr_b16 v[52:53], v20 offset:12608
    v_mfma_f32_16x16x32_bf16 v[242:245], v[54:57], v[114:117], v[242:245]
    v_mfma_f32_16x16x32_bf16 v[246:249], v[54:57], v[118:121], v[246:249]
    s_waitcnt lgkmcnt(4)
    v_mfma_f32_16x16x32_bf16 v[138:141], v[30:33], v[122:125], v[138:141]
    ds_read_b64_tr_b16 v[54:55], v21 offset:10752
    v_mfma_f32_16x16x32_bf16 v[142:145], v[30:33], v[126:129], v[142:145]
    ds_read_b64_tr_b16 v[56:57], v21 offset:12544
    v_mfma_f32_16x16x32_bf16 v[146:149], v[30:33], v[130:133], v[146:149]
    s_waitcnt vmcnt(13)
    v_accvgpr_read_b32 v106, a224
    v_accvgpr_read_b32 v110, a225
    v_mfma_f32_16x16x32_bf16 v[150:153], v[30:33], v[134:137], v[150:153]
    buffer_load_dwordx4 v[66:69], v12, s[48:51], s86 offen sc1
    v_mfma_f32_16x16x32_bf16 v[154:157], v[34:37], v[122:125], v[154:157]
    ds_read_b64_tr_b16 v[30:31], v17 offset:14336
    v_accvgpr_read_b32 v114, a226
    v_mfma_f32_16x16x32_bf16 v[158:161], v[34:37], v[126:129], v[158:161]
    ds_read_b64_tr_b16 v[32:33], v17 offset:16128
    v_accvgpr_read_b32 v118, a227
    v_mfma_f32_16x16x32_bf16 v[162:165], v[34:37], v[130:133], v[162:165]
    v_accvgpr_read_b32 v107, a228
    v_accvgpr_read_b32 v111, a229
    v_mfma_f32_16x16x32_bf16 v[166:169], v[34:37], v[134:137], v[166:169]
    buffer_load_dwordx4 a[224:227], v8, s[48:51], s80 offen sc1
    v_mfma_f32_16x16x32_bf16 v[170:173], v[38:41], v[122:125], v[170:173]
    ds_read_b64_tr_b16 v[34:35], v17 offset:14368
    v_accvgpr_read_b32 v115, a230
    v_mfma_f32_16x16x32_bf16 v[174:177], v[38:41], v[126:129], v[174:177]
    ds_read_b64_tr_b16 v[36:37], v17 offset:16160
    v_accvgpr_read_b32 v119, a231
    v_mfma_f32_16x16x32_bf16 v[178:181], v[38:41], v[130:133], v[178:181]
    v_accvgpr_read_b32 v108, a232
    v_accvgpr_read_b32 v112, a233
    v_mfma_f32_16x16x32_bf16 v[182:185], v[38:41], v[134:137], v[182:185]
    buffer_load_dwordx4 a[228:231], v9, s[48:51], s80 offen sc1
    v_mfma_f32_16x16x32_bf16 v[186:189], v[42:45], v[122:125], v[186:189]
    ds_read_b64_tr_b16 v[38:39], v17 offset:14400
    v_accvgpr_read_b32 v116, a234
    v_mfma_f32_16x16x32_bf16 v[190:193], v[42:45], v[126:129], v[190:193]
    ds_read_b64_tr_b16 v[40:41], v17 offset:16192
    v_accvgpr_read_b32 v120, a235
    v_mfma_f32_16x16x32_bf16 v[194:197], v[42:45], v[130:133], v[194:197]
    v_accvgpr_read_b32 v109, a236
    v_accvgpr_read_b32 v113, a237
    v_mfma_f32_16x16x32_bf16 v[198:201], v[42:45], v[134:137], v[198:201]
    buffer_load_dwordx4 a[232:235], v10, s[48:51], s80 offen sc1
    s_waitcnt lgkmcnt(6)
    v_mfma_f32_16x16x32_bf16 v[202:205], v[46:49], v[122:125], v[202:205]
    ds_read_b64_tr_b16 v[42:43], v20 offset:14336
    v_accvgpr_read_b32 v117, a238
    v_mfma_f32_16x16x32_bf16 v[206:209], v[46:49], v[126:129], v[206:209]
    ds_read_b64_tr_b16 v[44:45], v20 offset:16128
    v_accvgpr_read_b32 v121, a239
    v_mfma_f32_16x16x32_bf16 v[210:213], v[46:49], v[130:133], v[210:213]
    buffer_load_dwordx4 v[70:73], v12, s[48:51], s93 offen sc1
    v_mfma_f32_16x16x32_bf16 v[214:217], v[46:49], v[134:137], v[214:217]
    buffer_load_dwordx4 a[236:239], v11, s[48:51], s80 offen sc1
    s_add_u32 s80, s80, 135168
    v_mfma_f32_16x16x32_bf16 v[218:221], v[50:53], v[122:125], v[218:221]
    ds_read_b64_tr_b16 v[46:47], v20 offset:14368
    s_waitcnt vmcnt(14)
    v_cmp_ne_u32 vcc, v18, v58
    v_mfma_f32_16x16x32_bf16 v[222:225], v[50:53], v[126:129], v[222:225]
    ds_read_b64_tr_b16 v[48:49], v20 offset:16160
    s_cbranch_vccnz L_slow5
L_ret7:
    v_mfma_f32_16x16x32_bf16 v[226:229], v[50:53], v[130:133], v[226:229]
    buffer_load_dwordx4 v[58:61], v5, s[48:51], s82 offen sc1
    v_mfma_f32_16x16x32_bf16 v[230:233], v[50:53], v[134:137], v[230:233]
    buffer_load_dwordx4 v[62:65], v5, s[48:51], s83 offen sc1
    v_mfma_f32_16x16x32_bf16 v[234:237], v[54:57], v[122:125], v[234:237]
    ds_read_b64_tr_b16 v[50:51], v20 offset:14400
    v_mfma_f32_16x16x32_bf16 v[238:241], v[54:57], v[126:129], v[238:241]
    ds_read_b64_tr_b16 v[52:53], v20 offset:16192
    v_mfma_f32_16x16x32_bf16 v[242:245], v[54:57], v[130:133], v[242:245]
    v_mfma_f32_16x16x32_bf16 v[246:249], v[54:57], v[134:137], v[246:249]
    s_waitcnt lgkmcnt(4)
    v_mfma_f32_16x16x32_bf16 v[138:141], v[30:33], v[106:109], v[138:141]
    ds_read_b64_tr_b16 v[54:55], v21 offset:14336
    v_mfma_f32_16x16x32_bf16 v[142:145], v[30:33], v[110:113], v[142:145]
    ds_read_b64_tr_b16 v[56:57], v21 offset:16128
    v_mfma_f32_16x16x32_bf16 v[146:149], v[30:33], v[114:117], v[146:149]
    v_mov_b32 v122, v74
    v_mov_b32 v126, v75
    v_mfma_f32_16x16x32_bf16 v[150:153], v[30:33], v[118:121], v[150:153]
    v_mfma_f32_16x16x32_bf16 v[154:157], v[34:37], v[106:109], v[154:157]
    ds_read_b64_tr_b16 v[30:31], v17 offset:17920
    v_mov_b32 v130, v76
    v_mfma_f32_16x16x32_bf16 v[158:161], v[34:37], v[110:113], v[158:161]
    ds_read_b64_tr_b16 v[32:33], v17 offset:19712
    v_mov_b32 v134, v77
    v_mfma_f32_16x16x32_bf16 v[162:165], v[34:37], v[114:117], v[162:165]
    v_mov_b32 v123, v78
    v_mov_b32 v127, v79
    v_mfma_f32_16x16x32_bf16 v[166:169], v[34:37], v[118:121], v[166:169]
    buffer_load_dwordx4 v[74:77], v8, s[48:51], s80 offen sc1
    v_mfma_f32_16x16x32_bf16 v[170:173], v[38:41], v[106:109], v[170:173]
    ds_read_b64_tr_b16 v[34:35], v17 offset:17952
    v_mov_b32 v131, v80
    v_mfma_f32_16x16x32_bf16 v[174:177], v[38:41], v[110:113], v[174:177]
    ds_read_b64_tr_b16 v[36:37], v17 offset:19744
    v_mov_b32 v135, v81
    v_mfma_f32_16x16x32_bf16 v[178:181], v[38:41], v[114:117], v[178:181]
    v_mov_b32 v124, v82
    v_mov_b32 v128, v83
    v_mfma_f32_16x16x32_bf16 v[182:185], v[38:41], v[118:121], v[182:185]
    buffer_load_dwordx4 v[78:81], v9, s[48:51], s80 offen sc1
    v_mfma_f32_16x16x32_bf16 v[186:189], v[42:45], v[106:109], v[186:189]
    ds_read_b64_tr_b16 v[38:39], v17 offset:17984
    v_mov_b32 v132, v84
    v_mfma_f32_16x16x32_bf16 v[190:193], v[42:45], v[110:113], v[190:193]
    ds_read_b64_tr_b16 v[40:41], v17 offset:19776
    v_mov_b32 v136, v85
    v_mfma_f32_16x16x32_bf16 v[194:197], v[42:45], v[114:117], v[194:197]
    v_mov_b32 v125, v86
    v_mov_b32 v129, v87
    v_mfma_f32_16x16x32_bf16 v[198:201], v[42:45], v[118:121], v[198:201]
    buffer_load_dwordx4 v[82:85], v10, s[48:51], s80 offen sc1
    s_waitcnt lgkmcnt(6)
    v_mfma_f32_16x16x32_bf16 v[202:205], v[46:49], v[106:109], v[202:205]
    ds_read_b64_tr_b16 v[42:43], v20 offset:17920
    v_mov_b32 v133, v88
    v_mfma_f32_16x16x32_bf16 v[206:209], v[46:49], v[110:113], v[206:209]
    ds_read_b64_tr_b16 v[44:45], v20 offset:19712
    v_mov_b32 v137, v89
    v_mfma_f32_16x16x32_bf16 v[210:213], v[46:49], v[114:117], v[210:213]
    v_mfma_f32_16x16x32_bf16 v[214:217], v[46:49], v[118:121], v[214:217]
    buffer_load_dwordx4 v[86:89], v11, s[48:51], s80 offen sc1
    s_add_u32 s80, s80, 135168
    v_mfma_f32_16x16x32_bf16 v[218:221], v[50:53], v[106:109], v[218:221]
    ds_read_b64_tr_b16 v[46:47], v20 offset:17952
    v_mfma_f32_16x16x32_bf16 v[222:225], v[50:53], v[110:113], v[222:225]
    ds_read_b64_tr_b16 v[48:49], v20 offset:19744
    v_mfma_f32_16x16x32_bf16 v[226:229], v[50:53], v[114:117], v[226:229]
    v_mfma_f32_16x16x32_bf16 v[230:233], v[50:53], v[118:121], v[230:233]
    v_mfma_f32_16x16x32_bf16 v[234:237], v[54:57], v[106:109], v[234:237]
    ds_read_b64_tr_b16 v[50:51], v20 offset:17984
    v_mfma_f32_16x16x32_bf16 v[238:241], v[54:57], v[110:113], v[238:241]
    ds_read_b64_tr_b16 v[52:53], v20 offset:19776
    v_mfma_f32_16x16x32_bf16 v[242:245], v[54:57], v[114:117], v[242:245]
    v_mfma_f32_16x16x32_bf16 v[246:249], v[54:57], v[118:121], v[246:249]
    s_waitcnt lgkmcnt(4)
    v_mfma_f32_16x16x32_bf16 v[138:141], v[30:33], v[122:125], v[138:141]
    ds_read_b64_tr_b16 v[54:55], v21 offset:17920
    s_waitcnt vmcnt(7)
    v_pk_add_f32 v[66:67], v[66:67], v[70:71]
    v_mfma_f32_16x16x32_bf16 v[142:145], v[30:33], v[126:129], v[142:145]
    ds_read_b64_tr_b16 v[56:57], v21 offset:19712
    v_pk_add_f32 v[68:69], v[68:69], v[72:73]
    v_mfma_f32_16x16x32_bf16 v[146:149], v[30:33], v[130:133], v[146:149]
    v_accvgpr_read_b32 v106, a240
    v_accvgpr_read_b32 v110, a241
    v_mfma_f32_16x16x32_bf16 v[150:153], v[30:33], v[134:137], v[150:153]
    s_lshl_b32 s8, s5, 8
    s_add_u32 s8, s8, 0
    v_lshl_add_u32 v12, v2, 4, s8
    v_lshl_add_u32 v12, v3, 2, v12
    v_mfma_f32_16x16x32_bf16 v[154:157], v[34:37], v[122:125], v[154:157]
    ds_read_b64_tr_b16 v[30:31], v17 offset:21504
    v_accvgpr_read_b32 v114, a242
    v_mfma_f32_16x16x32_bf16 v[158:161], v[34:37], v[126:129], v[158:161]
    ds_read_b64_tr_b16 v[32:33], v17 offset:23296
    v_accvgpr_read_b32 v118, a243
    v_mfma_f32_16x16x32_bf16 v[162:165], v[34:37], v[130:133], v[162:165]
    v_accvgpr_read_b32 v107, a244
    v_accvgpr_read_b32 v111, a245
    v_mfma_f32_16x16x32_bf16 v[166:169], v[34:37], v[134:137], v[166:169]
    buffer_load_dwordx4 a[240:243], v8, s[48:51], s80 offen sc1
    v_mfma_f32_16x16x32_bf16 v[170:173], v[38:41], v[122:125], v[170:173]
    ds_read_b64_tr_b16 v[34:35], v17 offset:21536
    v_accvgpr_read_b32 v115, a246
    v_mfma_f32_16x16x32_bf16 v[174:177], v[38:41], v[126:129], v[174:177]
    ds_read_b64_tr_b16 v[36:37], v17 offset:23328
    v_accvgpr_read_b32 v119, a247
    v_mfma_f32_16x16x32_bf16 v[178:181], v[38:41], v[130:133], v[178:181]
    v_accvgpr_read_b32 v108, a248
    v_accvgpr_read_b32 v112, a249
    v_mfma_f32_16x16x32_bf16 v[182:185], v[38:41], v[134:137], v[182:185]
    buffer_load_dwordx4 a[244:247], v9, s[48:51], s80 offen sc1
    v_mfma_f32_16x16x32_bf16 v[186:189], v[42:45], v[122:125], v[186:189]
    ds_read_b64_tr_b16 v[38:39], v17 offset:21568
    v_accvgpr_read_b32 v116, a250
    v_mfma_f32_16x16x32_bf16 v[190:193], v[42:45], v[126:129], v[190:193]
    ds_read_b64_tr_b16 v[40:41], v17 offset:23360
    v_accvgpr_read_b32 v120, a251
    v_mfma_f32_16x16x32_bf16 v[194:197], v[42:45], v[130:133], v[194:197]
    v_accvgpr_read_b32 v109, a252
    v_accvgpr_read_b32 v113, a253
    v_mfma_f32_16x16x32_bf16 v[198:201], v[42:45], v[134:137], v[198:201]
    buffer_load_dwordx4 a[248:251], v10, s[48:51], s80 offen sc1
    s_waitcnt lgkmcnt(6)
    v_mfma_f32_16x16x32_bf16 v[202:205], v[46:49], v[122:125], v[202:205]
    ds_read_b64_tr_b16 v[42:43], v20 offset:21504
    v_accvgpr_read_b32 v117, a254
    v_mfma_f32_16x16x32_bf16 v[206:209], v[46:49], v[126:129], v[206:209]
    ds_read_b64_tr_b16 v[44:45], v20 offset:23296
    v_accvgpr_read_b32 v121, a255
    v_mfma_f32_16x16x32_bf16 v[210:213], v[46:49], v[130:133], v[210:213]
    v_permlane32_swap_b32 v66, v68
    v_permlane32_swap_b32 v67, v69
    v_mfma_f32_16x16x32_bf16 v[214:217], v[46:49], v[134:137], v[214:217]
    buffer_load_dwordx4 a[252:255], v11, s[48:51], s80 offen sc1
    s_add_u32 s80, s80, 135168
    v_mfma_f32_16x16x32_bf16 v[218:221], v[50:53], v[122:125], v[218:221]
    ds_read_b64_tr_b16 v[46:47], v20 offset:21536
    v_pk_add_f32 v[66:67], v[66:67], v[68:69]
    v_mfma_f32_16x16x32_bf16 v[222:225], v[50:53], v[126:129], v[222:225]
    ds_read_b64_tr_b16 v[48:49], v20 offset:23328
    v_mfma_f32_16x16x32_bf16 v[226:229], v[50:53], v[130:133], v[226:229]
    v_permlane16_swap_b32 v66, v67
    v_mfma_f32_16x16x32_bf16 v[230:233], v[50:53], v[134:137], v[230:233]
    v_add_f32 v66, v66, v67
    ds_write_b32 v12, v66
    v_mfma_f32_16x16x32_bf16 v[234:237], v[54:57], v[122:125], v[234:237]
    ds_read_b64_tr_b16 v[50:51], v20 offset:21568
    s_waitcnt vmcnt(9)
    v_dot2_f32_bf16 v66, v58, s9, 0
    v_mfma_f32_16x16x32_bf16 v[238:241], v[54:57], v[126:129], v[238:241]
    ds_read_b64_tr_b16 v[52:53], v20 offset:23360
    v_dot2_f32_bf16 v70, v58, v58, 0
    v_mfma_f32_16x16x32_bf16 v[242:245], v[54:57], v[130:133], v[242:245]
    v_dot2_f32_bf16 v67, v59, s9, 0
    v_dot2_f32_bf16 v71, v59, v59, 0
    v_mfma_f32_16x16x32_bf16 v[246:249], v[54:57], v[134:137], v[246:249]
    v_dot2_f32_bf16 v68, v60, s9, 0
    v_dot2_f32_bf16 v72, v60, v60, 0
    s_waitcnt lgkmcnt(5)
    v_mfma_f32_16x16x32_bf16 v[138:141], v[30:33], v[106:109], v[138:141]
    ds_read_b64_tr_b16 v[54:55], v21 offset:21504
    v_dot2_f32_bf16 v69, v61, s9, 0
    v_mfma_f32_16x16x32_bf16 v[142:145], v[30:33], v[110:113], v[142:145]
    ds_read_b64_tr_b16 v[56:57], v21 offset:23296
    v_dot2_f32_bf16 v73, v61, v61, 0
    v_mfma_f32_16x16x32_bf16 v[146:149], v[30:33], v[114:117], v[146:149]
    v_mov_b32 v122, v90
    v_mov_b32 v126, v91
    v_mfma_f32_16x16x32_bf16 v[150:153], v[30:33], v[118:121], v[150:153]
    buffer_load_dwordx4 a[0:3], v6, s[48:51], s94 offen offset:0 sc1
    v_mfma_f32_16x16x32_bf16 v[154:157], v[34:37], v[106:109], v[154:157]
    ds_read_b64_tr_b16 v[30:31], v17 offset:25088
    v_mov_b32 v130, v92
    v_mfma_f32_16x16x32_bf16 v[158:161], v[34:37], v[110:113], v[158:161]
    ds_read_b64_tr_b16 v[32:33], v17 offset:26880
    v_mov_b32 v134, v93
    v_mfma_f32_16x16x32_bf16 v[162:165], v[34:37], v[114:117], v[162:165]
    v_mov_b32 v123, v94
    v_mov_b32 v127, v95
    v_mfma_f32_16x16x32_bf16 v[166:169], v[34:37], v[118:121], v[166:169]
    buffer_load_dwordx4 v[90:93], v8, s[48:51], s80 offen sc1
    v_mfma_f32_16x16x32_bf16 v[170:173], v[38:41], v[106:109], v[170:173]
    ds_read_b64_tr_b16 v[34:35], v17 offset:25120
    v_mov_b32 v131, v96
    v_mfma_f32_16x16x32_bf16 v[174:177], v[38:41], v[110:113], v[174:177]
    ds_read_b64_tr_b16 v[36:37], v17 offset:26912
    v_mov_b32 v135, v97
    v_mfma_f32_16x16x32_bf16 v[178:181], v[38:41], v[114:117], v[178:181]
    v_mov_b32 v124, v98
    v_mov_b32 v128, v99
    v_mfma_f32_16x16x32_bf16 v[182:185], v[38:41], v[118:121], v[182:185]
    buffer_load_dwordx4 v[94:97], v9, s[48:51], s80 offen sc1
    v_mfma_f32_16x16x32_bf16 v[186:189], v[42:45], v[106:109], v[186:189]
    ds_read_b64_tr_b16 v[38:39], v17 offset:25152
    v_mov_b32 v132, v100
    v_mfma_f32_16x16x32_bf16 v[190:193], v[42:45], v[110:113], v[190:193]
    ds_read_b64_tr_b16 v[40:41], v17 offset:26944
    v_mov_b32 v136, v101
    v_mfma_f32_16x16x32_bf16 v[194:197], v[42:45], v[114:117], v[194:197]
    v_mov_b32 v125, v102
    v_mov_b32 v129, v103
    v_mfma_f32_16x16x32_bf16 v[198:201], v[42:45], v[118:121], v[198:201]
    buffer_load_dwordx4 v[98:101], v10, s[48:51], s80 offen sc1
    s_waitcnt lgkmcnt(6)
    v_mfma_f32_16x16x32_bf16 v[202:205], v[46:49], v[106:109], v[202:205]
    ds_read_b64_tr_b16 v[42:43], v20 offset:25088
    v_mov_b32 v133, v104
    v_mfma_f32_16x16x32_bf16 v[206:209], v[46:49], v[110:113], v[206:209]
    ds_read_b64_tr_b16 v[44:45], v20 offset:26880
    v_mov_b32 v137, v105
    v_mfma_f32_16x16x32_bf16 v[210:213], v[46:49], v[114:117], v[210:213]
    s_waitcnt vmcnt(12)
    v_dot2_f32_bf16 v66, v62, s9, v66
    v_dot2_f32_bf16 v70, v62, v62, v70
    v_mfma_f32_16x16x32_bf16 v[214:217], v[46:49], v[118:121], v[214:217]
    buffer_load_dwordx4 v[102:105], v11, s[48:51], s80 offen sc1
    s_add_u32 s80, s80, 135168
    v_mfma_f32_16x16x32_bf16 v[218:221], v[50:53], v[106:109], v[218:221]
    ds_read_b64_tr_b16 v[46:47], v20 offset:25120
    v_dot2_f32_bf16 v67, v63, s9, v67
    v_mfma_f32_16x16x32_bf16 v[222:225], v[50:53], v[110:113], v[222:225]
    ds_read_b64_tr_b16 v[48:49], v20 offset:26912
    v_dot2_f32_bf16 v71, v63, v63, v71
    v_mfma_f32_16x16x32_bf16 v[226:229], v[50:53], v[114:117], v[226:229]
    v_dot2_f32_bf16 v68, v64, s9, v68
    v_dot2_f32_bf16 v72, v64, v64, v72
    v_mfma_f32_16x16x32_bf16 v[230:233], v[50:53], v[118:121], v[230:233]
    buffer_load_dwordx4 a[4:7], v6, s[48:51], s94 offen offset:1024 sc1
    v_mfma_f32_16x16x32_bf16 v[234:237], v[54:57], v[106:109], v[234:237]
    ds_read_b64_tr_b16 v[50:51], v20 offset:25152
    v_dot2_f32_bf16 v69, v65, s9, v69
    v_mfma_f32_16x16x32_bf16 v[238:241], v[54:57], v[110:113], v[238:241]
    ds_read_b64_tr_b16 v[52:53], v20 offset:26944
    v_dot2_f32_bf16 v73, v65, v65, v73
    v_mfma_f32_16x16x32_bf16 v[242:245], v[54:57], v[114:117], v[242:245]
    v_permlane32_swap_b32 v66, v67
    v_permlane32_swap_b32 v68, v69
    v_mfma_f32_16x16x32_bf16 v[246:249], v[54:57], v[118:121], v[246:249]
    buffer_load_dwordx4 a[8:11], v6, s[48:51], s94 offen offset:2048 sc1
    s_waitcnt lgkmcnt(4)
    v_mfma_f32_16x16x32_bf16 v[138:141], v[30:33], v[122:125], v[138:141]
    ds_read_b64_tr_b16 v[54:55], v21 offset:25088
    v_permlane32_swap_b32 v70, v71
    v_mfma_f32_16x16x32_bf16 v[142:145], v[30:33], v[126:129], v[142:145]
    ds_read_b64_tr_b16 v[56:57], v21 offset:26880
    v_permlane32_swap_b32 v72, v73
    v_mfma_f32_16x16x32_bf16 v[146:149], v[30:33], v[130:133], v[146:149]
    v_accvgpr_read_b32 v106, a224
    v_accvgpr_read_b32 v110, a225
    v_mfma_f32_16x16x32_bf16 v[150:153], v[30:33], v[134:137], v[150:153]
    buffer_load_dwordx4 a[12:15], v6, s[48:51], s94 offen offset:3072 sc1
    s_add_u32 s94, s94, 4096
    v_mfma_f32_16x16x32_bf16 v[154:157], v[34:37], v[122:125], v[154:157]
    ds_read_b64_tr_b16 v[30:31], v17 offset:28672
    v_accvgpr_read_b32 v114, a226
    v_mfma_f32_16x16x32_bf16 v[158:161], v[34:37], v[126:129], v[158:161]
    ds_read_b64_tr_b16 v[32:33], v17 offset:30464
    v_accvgpr_read_b32 v118, a227
    v_mfma_f32_16x16x32_bf16 v[162:165], v[34:37], v[130:133], v[162:165]
    v_accvgpr_read_b32 v107, a228
    v_accvgpr_read_b32 v111, a229
    v_mfma_f32_16x16x32_bf16 v[166:169], v[34:37], v[134:137], v[166:169]
    buffer_load_dwordx4 a[224:227], v8, s[48:51], s80 offen sc1
    v_mfma_f32_16x16x32_bf16 v[170:173], v[38:41], v[122:125], v[170:173]
    ds_read_b64_tr_b16 v[34:35], v17 offset:28704
    v_accvgpr_read_b32 v115, a230
    v_mfma_f32_16x16x32_bf16 v[174:177], v[38:41], v[126:129], v[174:177]
    ds_read_b64_tr_b16 v[36:37], v17 offset:30496
    v_accvgpr_read_b32 v119, a231
    v_mfma_f32_16x16x32_bf16 v[178:181], v[38:41], v[130:133], v[178:181]
    v_accvgpr_read_b32 v108, a232
    v_accvgpr_read_b32 v112, a233
    v_mfma_f32_16x16x32_bf16 v[182:185], v[38:41], v[134:137], v[182:185]
    buffer_load_dwordx4 a[228:231], v9, s[48:51], s80 offen sc1
    v_mfma_f32_16x16x32_bf16 v[186:189], v[42:45], v[122:125], v[186:189]
    ds_read_b64_tr_b16 v[38:39], v17 offset:28736
    v_accvgpr_read_b32 v116, a234
    v_mfma_f32_16x16x32_bf16 v[190:193], v[42:45], v[126:129], v[190:193]
    ds_read_b64_tr_b16 v[40:41], v17 offset:30528
    v_accvgpr_read_b32 v120, a235
    v_mfma_f32_16x16x32_bf16 v[194:197], v[42:45], v[130:133], v[194:197]
    v_accvgpr_read_b32 v109, a236
    v_accvgpr_read_b32 v113, a237
    v_mfma_f32_16x16x32_bf16 v[198:201], v[42:45], v[134:137], v[198:201]
    buffer_load_dwordx4 a[232:235], v10, s[48:51], s80 offen sc1
    s_waitcnt lgkmcnt(6)
    v_mfma_f32_16x16x32_bf16 v[202:205], v[46:49], v[122:125], v[202:205]
    ds_read_b64_tr_b16 v[42:43], v20 offset:28672
    v_accvgpr_read_b32 v117, a238
    v_mfma_f32_16x16x32_bf16 v[206:209], v[46:49], v[126:129], v[206:209]
    ds_read_b64_tr_b16 v[44:45], v20 offset:30464
    v_accvgpr_read_b32 v121, a239
    v_mfma_f32_16x16x32_bf16 v[210:213], v[46:49], v[130:133], v[210:213]
    v_add_f32 v66, v66, v67
    v_add_f32 v68, v68, v69
    v_mfma_f32_16x16x32_bf16 v[214:217], v[46:49], v[134:137], v[214:217]
    buffer_load_dwordx4 a[236:239], v11, s[48:51], s80 offen sc1
    s_add_u32 s80, s80, 135168
    v_mfma_f32_16x16x32_bf16 v[218:221], v[50:53], v[122:125], v[218:221]
    ds_read_b64_tr_b16 v[46:47], v20 offset:28704
    v_add_f32 v70, v70, v71
    v_mfma_f32_16x16x32_bf16 v[222:225], v[50:53], v[126:129], v[222:225]
    ds_read_b64_tr_b16 v[48:49], v20 offset:30496
    v_add_f32 v72, v72, v73
    v_mfma_f32_16x16x32_bf16 v[226:229], v[50:53], v[130:133], v[226:229]
    v_permlane16_swap_b32 v66, v68
    v_permlane16_swap_b32 v70, v72
    v_mfma_f32_16x16x32_bf16 v[230:233], v[50:53], v[134:137], v[230:233]
    buffer_load_dwordx4 a[16:19], v6, s[48:51], s94 offen offset:0 sc1
    v_mfma_f32_16x16x32_bf16 v[234:237], v[54:57], v[122:125], v[234:237]
    ds_read_b64_tr_b16 v[50:51], v20 offset:28736
    v_add_f32 v66, v66, v68
    v_mfma_f32_16x16x32_bf16 v[238:241], v[54:57], v[126:129], v[238:241]
    ds_read_b64_tr_b16 v[52:53], v20 offset:30528
    v_add_f32 v67, v70, v72
    v_mfma_f32_16x16x32_bf16 v[242:245], v[54:57], v[130:133], v[242:245]
    v_add_f32_dpp v66, v66, v66 row_ror:8 row_mask:0xf bank_mask:0xf
    v_add_f32_dpp v67, v67, v67 row_ror:8 row_mask:0xf bank_mask:0xf
    v_mfma_f32_16x16x32_bf16 v[246:249], v[54:57], v[134:137], v[246:249]
    buffer_load_dwordx4 a[20:23], v6, s[48:51], s94 offen offset:1024 sc1
    s_waitcnt lgkmcnt(4)
    v_mfma_f32_16x16x32_bf16 v[138:141], v[30:33], v[106:109], v[138:141]
    ds_read_b64_tr_b16 v[54:55], v21 offset:28672
    v_add_f32_dpp v66, v66, v66 row_ror:4 row_mask:0xf bank_mask:0xf
    v_mfma_f32_16x16x32_bf16 v[142:145], v[30:33], v[110:113], v[142:145]
    ds_read_b64_tr_b16 v[56:57], v21 offset:30464
    v_add_f32_dpp v67, v67, v67 row_ror:4 row_mask:0xf bank_mask:0xf
    v_mfma_f32_16x16x32_bf16 v[146:149], v[30:33], v[114:117], v[146:149]
    s_waitcnt vmcnt(18)
    v_mov_b32 v122, v74
    v_mov_b32 v126, v75
    v_mfma_f32_16x16x32_bf16 v[150:153], v[30:33], v[118:121], v[150:153]
    buffer_load_dwordx4 a[24:27], v6, s[48:51], s94 offen offset:2048 sc1
    v_mfma_f32_16x16x32_bf16 v[154:157], v[34:37], v[106:109], v[154:157]
    ds_read_b64_tr_b16 v[30:31], v17 offset:32256
    v_mov_b32 v130, v76
    v_mfma_f32_16x16x32_bf16 v[158:161], v[34:37], v[110:113], v[158:161]
    ds_read_b64_tr_b16 v[32:33], v17 offset:34048
    v_mov_b32 v134, v77
    v_mfma_f32_16x16x32_bf16 v[162:165], v[34:37], v[114:117], v[162:165]
    v_mov_b32 v123, v78
    v_mov_b32 v127, v79
    v_mfma_f32_16x16x32_bf16 v[166:169], v[34:37], v[118:121], v[166:169]
    buffer_load_dwordx4 v[74:77], v8, s[48:51], s80 offen sc1
    v_mfma_f32_16x16x32_bf16 v[170:173], v[38:41], v[106:109], v[170:173]
    ds_read_b64_tr_b16 v[34:35], v17 offset:32288
    v_mov_b32 v131, v80
    v_mfma_f32_16x16x32_bf16 v[174:177], v[38:41], v[110:113], v[174:177]
    ds_read_b64_tr_b16 v[36:37], v17 offset:34080
    v_mov_b32 v135, v81
    v_mfma_f32_16x16x32_bf16 v[178:181], v[38:41], v[114:117], v[178:181]
    v_mov_b32 v124, v82
    v_mov_b32 v128, v83
    v_mfma_f32_16x16x32_bf16 v[182:185], v[38:41], v[118:121], v[182:185]
    buffer_load_dwordx4 v[78:81], v9, s[48:51], s80 offen sc1
    v_mfma_f32_16x16x32_bf16 v[186:189], v[42:45], v[106:109], v[186:189]
    ds_read_b64_tr_b16 v[38:39], v17 offset:32320
    v_mov_b32 v132, v84
    v_mfma_f32_16x16x32_bf16 v[190:193], v[42:45], v[110:113], v[190:193]
    ds_read_b64_tr_b16 v[40:41], v17 offset:34112
    v_mov_b32 v136, v85
    v_mfma_f32_16x16x32_bf16 v[194:197], v[42:45], v[114:117], v[194:197]
    v_mov_b32 v125, v86
    v_mov_b32 v129, v87
    v_mfma_f32_16x16x32_bf16 v[198:201], v[42:45], v[118:121], v[198:201]
    buffer_load_dwordx4 v[82:85], v10, s[48:51], s80 offen sc1
    s_waitcnt lgkmcnt(6)
    v_mfma_f32_16x16x32_bf16 v[202:205], v[46:49], v[106:109], v[202:205]
    ds_read_b64_tr_b16 v[42:43], v20 offset:32256
    v_mov_b32 v133, v88
    v_mfma_f32_16x16x32_bf16 v[206:209], v[46:49], v[110:113], v[206:209]
    ds_read_b64_tr_b16 v[44:45], v20 offset:34048
    v_mov_b32 v137, v89
    v_mfma_f32_16x16x32_bf16 v[210:213], v[46:49], v[114:117], v[210:213]
    v_add_f32_dpp v66, v66, v66 row_ror:2 row_mask:0xf bank_mask:0xf
    v_add_f32_dpp v67, v67, v67 row_ror:2 row_mask:0xf bank_mask:0xf
    v_mfma_f32_16x16x32_bf16 v[214:217], v[46:49], v[118:121], v[214:217]
    buffer_load_dwordx4 v[86:89], v11, s[48:51], s80 offen sc1
    s_add_u32 s80, s80, 135168
    v_mfma_f32_16x16x32_bf16 v[218:221], v[50:53], v[106:109], v[218:221]
    ds_read_b64_tr_b16 v[46:47], v20 offset:32288
    s_mov_b32 exec_lo, 0x00030003
    s_mov_b32 exec_hi, 0x00030003
    ds_write_b64 v24, v[66:67]
    s_mov_b64 exec, -1
    v_mfma_f32_16x16x32_bf16 v[222:225], v[50:53], v[110:113], v[222:225]
    ds_read_b64_tr_b16 v[48:49], v20 offset:34080
    v_mfma_f32_16x16x32_bf16 v[226:229], v[50:53], v[114:117], v[226:229]
    v_mfma_f32_16x16x32_bf16 v[230:233], v[50:53], v[118:121], v[230:233]
    buffer_load_dwordx4 a[28:31], v6, s[48:51], s94 offen offset:3072 sc1
    s_add_u32 s94, s94, 4096
    v_mfma_f32_16x16x32_bf16 v[234:237], v[54:57], v[106:109], v[234:237]
    ds_read_b64_tr_b16 v[50:51], v20 offset:32320
    v_mfma_f32_16x16x32_bf16 v[238:241], v[54:57], v[110:113], v[238:241]
    ds_read_b64_tr_b16 v[52:53], v20 offset:34112
    v_mfma_f32_16x16x32_bf16 v[242:245], v[54:57], v[114:117], v[242:245]
    v_mfma_f32_16x16x32_bf16 v[246:249], v[54:57], v[118:121], v[246:249]
    buffer_load_dwordx4 a[32:35], v6, s[48:51], s94 offen offset:0 sc1
    s_waitcnt lgkmcnt(3)
    s_barrier
    v_mfma_f32_16x16x32_bf16 v[138:141], v[30:33], v[122:125], v[138:141]
    ds_read_b64_tr_b16 v[54:55], v21 offset:32256
    ds_read_b64 v[66:67], v25 offset:0
    v_mfma_f32_16x16x32_bf16 v[142:145], v[30:33], v[126:129], v[142:145]
    ds_read_b64_tr_b16 v[56:57], v21 offset:34048
    ds_read_b64 v[68:69], v25 offset:64
    v_mfma_f32_16x16x32_bf16 v[146:149], v[30:33], v[130:133], v[146:149]
    s_waitcnt vmcnt(21)
    v_accvgpr_read_b32 v106, a240
    v_accvgpr_read_b32 v110, a241
    v_mfma_f32_16x16x32_bf16 v[150:153], v[30:33], v[134:137], v[150:153]
    buffer_load_dwordx4 a[36:39], v6, s[48:51], s94 offen offset:1024 sc1
    v_mfma_f32_16x16x32_bf16 v[154:157], v[34:37], v[122:125], v[154:157]
    ds_read_b64_tr_b16 v[30:31], v17 offset:35840
    v_accvgpr_read_b32 v114, a242
    v_mfma_f32_16x16x32_bf16 v[158:161], v[34:37], v[126:129], v[158:161]
    ds_read_b64_tr_b16 v[32:33], v17 offset:37632
    v_accvgpr_read_b32 v118, a243
    v_mfma_f32_16x16x32_bf16 v[162:165], v[34:37], v[130:133], v[162:165]
    v_accvgpr_read_b32 v107, a244
    v_accvgpr_read_b32 v111, a245
    v_mfma_f32_16x16x32_bf16 v[166:169], v[34:37], v[134:137], v[166:169]
    buffer_load_dwordx4 a[240:243], v8, s[48:51], s80 offen sc1
    v_mfma_f32_16x16x32_bf16 v[170:173], v[38:41], v[122:125], v[170:173]
    ds_read_b64_tr_b16 v[34:35], v17 offset:35872
    v_accvgpr_read_b32 v115, a246
    v_mfma_f32_16x16x32_bf16 v[174:177], v[38:41], v[126:129], v[174:177]
    ds_read_b64_tr_b16 v[36:37], v17 offset:37664
    v_accvgpr_read_b32 v119, a247
    v_mfma_f32_16x16x32_bf16 v[178:181], v[38:41], v[130:133], v[178:181]
    v_accvgpr_read_b32 v108, a248
    v_accvgpr_read_b32 v112, a249
    v_mfma_f32_16x16x32_bf16 v[182:185], v[38:41], v[134:137], v[182:185]
    buffer_load_dwordx4 a[244:247], v9, s[48:51], s80 offen sc1
    v_mfma_f32_16x16x32_bf16 v[186:189], v[42:45], v[122:125], v[186:189]
    ds_read_b64_tr_b16 v[38:39], v17 offset:35904
    v_accvgpr_read_b32 v116, a250
    v_mfma_f32_16x16x32_bf16 v[190:193], v[42:45], v[126:129], v[190:193]
    ds_read_b64_tr_b16 v[40:41], v17 offset:37696
    v_accvgpr_read_b32 v120, a251
    v_mfma_f32_16x16x32_bf16 v[194:197], v[42:45], v[130:133], v[194:197]
    v_accvgpr_read_b32 v109, a252
    v_accvgpr_read_b32 v113, a253
    v_mfma_f32_16x16x32_bf16 v[198:201], v[42:45], v[134:137], v[198:201]
    buffer_load_dwordx4 a[248:251], v10, s[48:51], s80 offen sc1
    s_waitcnt lgkmcnt(7)
    v_mfma_f32_16x16x32_bf16 v[202:205], v[46:49], v[122:125], v[202:205]
    ds_read_b64_tr_b16 v[42:43], v20 offset:35840
    v_accvgpr_read_b32 v117, a254
    v_mfma_f32_16x16x32_bf16 v[206:209], v[46:49], v[126:129], v[206:209]
    ds_read_b64_tr_b16 v[44:45], v20 offset:37632
    v_accvgpr_read_b32 v121, a255
    v_mfma_f32_16x16x32_bf16 v[210:213], v[46:49], v[130:133], v[210:213]
    ds_read_b64 v[70:71], v25 offset:128
    ds_read_b64 v[72:73], v25 offset:192
    v_mfma_f32_16x16x32_bf16 v[214:217], v[46:49], v[134:137], v[214:217]
    buffer_load_dwordx4 a[252:255], v11, s[48:51], s80 offen sc1
    s_add_u32 s80, s80, 135168
    v_mfma_f32_16x16x32_bf16 v[218:221], v[50:53], v[122:125], v[218:221]
    ds_read_b64_tr_b16 v[46:47], v20 offset:35872
    v_mfma_f32_16x16x32_bf16 v[222:225], v[50:53], v[126:129], v[222:225]
    ds_read_b64_tr_b16 v[48:49], v20 offset:37664
    v_mfma_f32_16x16x32_bf16 v[226:229], v[50:53], v[130:133], v[226:229]
    v_mfma_f32_16x16x32_bf16 v[230:233], v[50:53], v[134:137], v[230:233]
    buffer_load_dwordx4 a[40:43], v6, s[48:51], s94 offen offset:2048 sc1
    v_mfma_f32_16x16x32_bf16 v[234:237], v[54:57], v[122:125], v[234:237]
    ds_read_b64_tr_b16 v[50:51], v20 offset:35904
    s_waitcnt lgkmcnt(13)
    v_pk_add_f32 v[66:67], v[66:67], v[68:69]
    v_mfma_f32_16x16x32_bf16 v[238:241], v[54:57], v[126:129], v[238:241]
    ds_read_b64_tr_b16 v[52:53], v20 offset:37696
    s_waitcnt lgkmcnt(4)
    v_pk_add_f32 v[70:71], v[70:71], v[72:73]
    v_mfma_f32_16x16x32_bf16 v[242:245], v[54:57], v[130:133], v[242:245]
    v_pk_add_f32 v[66:67], v[66:67], v[70:71]
    v_bfe_u32 v4, v0, 0, 3
    v_mfma_f32_16x16x32_bf16 v[246:249], v[54:57], v[134:137], v[246:249]
    buffer_load_dwordx4 a[44:47], v6, s[48:51], s94 offen offset:3072 sc1
    s_add_u32 s94, s94, 4096
    v_mfma_f32_16x16x32_bf16 v[138:141], v[30:33], v[106:109], v[138:141]
    ds_read_b64_tr_b16 v[54:55], v21 offset:35840
    v_lshlrev_b32 v4, 2, v4
    v_mfma_f32_16x16x32_bf16 v[142:145], v[30:33], v[110:113], v[142:145]
    ds_read_b64_tr_b16 v[56:57], v21 offset:37632
    v_mul_f32 v66, 0x3b000000, v66
    v_mfma_f32_16x16x32_bf16 v[146:149], v[30:33], v[114:117], v[146:149]
    s_waitcnt vmcnt(23)
    v_mov_b32 v122, v90
    v_mov_b32 v126, v91
    v_mfma_f32_16x16x32_bf16 v[150:153], v[30:33], v[118:121], v[150:153]
    buffer_load_dwordx4 a[48:51], v6, s[48:51], s94 offen offset:0 sc1
    v_mfma_f32_16x16x32_bf16 v[154:157], v[34:37], v[106:109], v[154:157]
    ds_read_b64_tr_b16 v[30:31], v17 offset:39424
    v_mov_b32 v130, v92
    v_mfma_f32_16x16x32_bf16 v[158:161], v[34:37], v[110:113], v[158:161]
    ds_read_b64_tr_b16 v[32:33], v17 offset:41216
    v_mov_b32 v134, v93
    v_mfma_f32_16x16x32_bf16 v[162:165], v[34:37], v[114:117], v[162:165]
    v_mov_b32 v123, v94
    v_mov_b32 v127, v95
    v_mfma_f32_16x16x32_bf16 v[166:169], v[34:37], v[118:121], v[166:169]
    buffer_load_dwordx4 v[90:93], v8, s[48:51], s80 offen sc1
    v_mfma_f32_16x16x32_bf16 v[170:173], v[38:41], v[106:109], v[170:173]
    ds_read_b64_tr_b16 v[34:35], v17 offset:39456
    v_mov_b32 v131, v96
    v_mfma_f32_16x16x32_bf16 v[174:177], v[38:41], v[110:113], v[174:177]
    ds_read_b64_tr_b16 v[36:37], v17 offset:41248
    v_mov_b32 v135, v97
    v_mfma_f32_16x16x32_bf16 v[178:181], v[38:41], v[114:117], v[178:181]
    v_mov_b32 v124, v98
    v_mov_b32 v128, v99
    v_mfma_f32_16x16x32_bf16 v[182:185], v[38:41], v[118:121], v[182:185]
    buffer_load_dwordx4 v[94:97], v9, s[48:51], s80 offen sc1
    v_mfma_f32_16x16x32_bf16 v[186:189], v[42:45], v[106:109], v[186:189]
    ds_read_b64_tr_b16 v[38:39], v17 offset:39488
    v_mov_b32 v132, v100
    v_mfma_f32_16x16x32_bf16 v[190:193], v[42:45], v[110:113], v[190:193]
    ds_read_b64_tr_b16 v[40:41], v17 offset:41280
    v_mov_b32 v136, v101
    v_mfma_f32_16x16x32_bf16 v[194:197], v[42:45], v[114:117], v[194:197]
    v_mov_b32 v125, v102
    v_mov_b32 v129, v103
    v_mfma_f32_16x16x32_bf16 v[198:201], v[42:45], v[118:121], v[198:201]
    buffer_load_dwordx4 v[98:101], v10, s[48:51], s80 offen sc1
    s_waitcnt lgkmcnt(6)
    v_mfma_f32_16x16x32_bf16 v[202:205], v[46:49], v[106:109], v[202:205]
    ds_read_b64_tr_b16 v[42:43], v20 offset:39424
    v_mov_b32 v133, v104
    v_mfma_f32_16x16x32_bf16 v[206:209], v[46:49], v[110:113], v[206:209]
    ds_read_b64_tr_b16 v[44:45], v20 offset:41216
    v_mov_b32 v137, v105
    v_mfma_f32_16x16x32_bf16 v[210:213], v[46:49], v[114:117], v[210:213]
    v_mul_f32 v67, 0x3b000000, v67
    v_fma_f32 v67, -v66, v66, v67
    v_mfma_f32_16x16x32_bf16 v[214:217], v[46:49], v[118:121], v[214:217]
    buffer_load_dwordx4 v[102:105], v11, s[48:51], s80 offen sc1
    s_add_u32 s80, s80, 135168
    v_mfma_f32_16x16x32_bf16 v[218:221], v[50:53], v[106:109], v[218:221]
    ds_read_b64_tr_b16 v[46:47], v20 offset:39456
    v_max_f32 v67, 0, v67
    v_mfma_f32_16x16x32_bf16 v[222:225], v[50:53], v[110:113], v[222:225]
    ds_read_b64_tr_b16 v[48:49], v20 offset:41248
    v_cvt_pk_bf16_f32 v67, v67, v67
    v_mfma_f32_16x16x32_bf16 v[226:229], v[50:53], v[114:117], v[226:229]
    v_lshlrev_b32 v67, 16, v67
    v_add_f32 v67, 0x3727c5ac, v67
    v_mfma_f32_16x16x32_bf16 v[230:233], v[50:53], v[118:121], v[230:233]
    buffer_load_dwordx4 a[52:55], v6, s[48:51], s94 offen offset:1024 sc1
    v_mfma_f32_16x16x32_bf16 v[234:237], v[54:57], v[106:109], v[234:237]
    ds_read_b64_tr_b16 v[50:51], v20 offset:39488
    v_cvt_pk_bf16_f32 v67, v67, v67
    v_mfma_f32_16x16x32_bf16 v[238:241], v[54:57], v[110:113], v[238:241]
    ds_read_b64_tr_b16 v[52:53], v20 offset:41280
    v_lshlrev_b32 v67, 16, v67
    v_mfma_f32_16x16x32_bf16 v[242:245], v[54:57], v[114:117], v[242:245]
    v_sqrt_f32 v67, v67
    s_nop 0
    v_cvt_pk_bf16_f32 v66, v66, v67
    v_mfma_f32_16x16x32_bf16 v[246:249], v[54:57], v[118:121], v[246:249]
    buffer_load_dwordx4 a[56:59], v6, s[48:51], s94 offen offset:2048 sc1
    s_waitcnt lgkmcnt(4)
    v_mfma_f32_16x16x32_bf16 v[138:141], v[30:33], v[122:125], v[138:141]
    ds_read_b64_tr_b16 v[54:55], v21 offset:39424
    v_mfma_f32_16x16x32_bf16 v[142:145], v[30:33], v[126:129], v[142:145]
    ds_read_b64_tr_b16 v[56:57], v21 offset:41216
    v_mfma_f32_16x16x32_bf16 v[146:149], v[30:33], v[130:133], v[146:149]
    s_waitcnt vmcnt(23)
    v_accvgpr_read_b32 v106, a224
    v_accvgpr_read_b32 v110, a225
    v_mfma_f32_16x16x32_bf16 v[150:153], v[30:33], v[134:137], v[150:153]
    buffer_load_dwordx4 a[60:63], v6, s[48:51], s94 offen offset:3072 sc1
    s_add_u32 s94, s94, 4096
    v_mfma_f32_16x16x32_bf16 v[154:157], v[34:37], v[122:125], v[154:157]
    ds_read_b64_tr_b16 v[30:31], v17 offset:43008
    v_accvgpr_read_b32 v114, a226
    v_mfma_f32_16x16x32_bf16 v[158:161], v[34:37], v[126:129], v[158:161]
    ds_read_b64_tr_b16 v[32:33], v17 offset:44800
    v_accvgpr_read_b32 v118, a227
    v_mfma_f32_16x16x32_bf16 v[162:165], v[34:37], v[130:133], v[162:165]
    v_accvgpr_read_b32 v107, a228
    v_accvgpr_read_b32 v111, a229
    v_mfma_f32_16x16x32_bf16 v[166:169], v[34:37], v[134:137], v[166:169]
    buffer_load_dwordx4 a[64:67], v6, s[48:51], s94 offen offset:0 sc1
    v_mfma_f32_16x16x32_bf16 v[170:173], v[38:41], v[122:125], v[170:173]
    ds_read_b64_tr_b16 v[34:35], v17 offset:43040
    v_accvgpr_read_b32 v115, a230
    v_mfma_f32_16x16x32_bf16 v[174:177], v[38:41], v[126:129], v[174:177]
    ds_read_b64_tr_b16 v[36:37], v17 offset:44832
    v_accvgpr_read_b32 v119, a231
    v_mfma_f32_16x16x32_bf16 v[178:181], v[38:41], v[130:133], v[178:181]
    v_accvgpr_read_b32 v108, a232
    v_accvgpr_read_b32 v112, a233
    v_mfma_f32_16x16x32_bf16 v[182:185], v[38:41], v[134:137], v[182:185]
    buffer_load_dwordx4 a[68:71], v6, s[48:51], s94 offen offset:1024 sc1
    v_mfma_f32_16x16x32_bf16 v[186:189], v[42:45], v[122:125], v[186:189]
    ds_read_b64_tr_b16 v[38:39], v17 offset:43072
    v_accvgpr_read_b32 v116, a234
    v_mfma_f32_16x16x32_bf16 v[190:193], v[42:45], v[126:129], v[190:193]
    ds_read_b64_tr_b16 v[40:41], v17 offset:44864
    v_accvgpr_read_b32 v120, a235
    v_mfma_f32_16x16x32_bf16 v[194:197], v[42:45], v[130:133], v[194:197]
    v_accvgpr_read_b32 v109, a236
    v_accvgpr_read_b32 v113, a237
    v_mfma_f32_16x16x32_bf16 v[198:201], v[42:45], v[134:137], v[198:201]
    buffer_load_dwordx4 a[72:75], v6, s[48:51], s94 offen offset:2048 sc1
    s_waitcnt lgkmcnt(6)
    v_mfma_f32_16x16x32_bf16 v[202:205], v[46:49], v[122:125], v[202:205]
    ds_read_b64_tr_b16 v[42:43], v20 offset:43008
    v_accvgpr_read_b32 v117, a238
    v_mfma_f32_16x16x32_bf16 v[206:209], v[46:49], v[126:129], v[206:209]
    ds_read_b64_tr_b16 v[44:45], v20 offset:44800
    v_accvgpr_read_b32 v121, a239
    v_mfma_f32_16x16x32_bf16 v[210:213], v[46:49], v[130:133], v[210:213]
    s_mov_b64 exec, 0xff
    buffer_store_dword v66, v4, s[48:51], s85 offen sc1
    s_mov_b64 exec, -1
    v_mfma_f32_16x16x32_bf16 v[214:217], v[46:49], v[134:137], v[214:217]
    v_bfe_u32 v9, v0, 4, 1
    v_bfe_u32 v8, v0, 5, 1
    v_mfma_f32_16x16x32_bf16 v[218:221], v[50:53], v[122:125], v[218:221]
    ds_read_b64_tr_b16 v[46:47], v20 offset:43040
    v_mul_u32_u24 v10, 57344, v9
    v_mfma_f32_16x16x32_bf16 v[222:225], v[50:53], v[126:129], v[222:225]
    ds_read_b64_tr_b16 v[48:49], v20 offset:44832
    v_lshl_add_u32 v10, v2, 4, v10
    v_mfma_f32_16x16x32_bf16 v[226:229], v[50:53], v[130:133], v[226:229]
    v_lshl_add_u32 v10, v8, 8, v10
    v_lshl_add_u32 v9, v9, 1, v8
    v_mfma_f32_16x16x32_bf16 v[230:233], v[50:53], v[134:137], v[230:233]
    v_mul_u32_u24 v11, 57344, v9
    v_lshl_add_u32 v11, v2, 4, v11
    v_mfma_f32_16x16x32_bf16 v[234:237], v[54:57], v[122:125], v[234:237]
    ds_read_b64_tr_b16 v[50:51], v20 offset:43072
    v_mov_b32 v8, 1.0
    v_mfma_f32_16x16x32_bf16 v[238:241], v[54:57], v[126:129], v[238:241]
    ds_read_b64_tr_b16 v[52:53], v20 offset:44864
    v_mov_b32 v9, 1.0
    v_mfma_f32_16x16x32_bf16 v[242:245], v[54:57], v[130:133], v[242:245]
    s_add_u32 s80, s84, 57344
    s_add_u32 s82, s84, 114688
    v_mfma_f32_16x16x32_bf16 v[246:249], v[54:57], v[134:137], v[246:249]
    s_add_u32 s83, s84, 172032
    v_lshlrev_b32 v12, 4, v3
    s_waitcnt lgkmcnt(4)
    v_mfma_f32_16x16x32_bf16 v[138:141], v[30:33], v[106:109], v[138:141]
    ds_read_b64_tr_b16 v[54:55], v21 offset:43008
    v_mfma_f32_16x16x32_bf16 v[142:145], v[30:33], v[110:113], v[142:145]
    ds_read_b64_tr_b16 v[56:57], v21 offset:44800
    v_mfma_f32_16x16x32_bf16 v[146:149], v[30:33], v[114:117], v[146:149]
    s_waitcnt vmcnt(21)
    v_mov_b32 v122, v74
    v_mov_b32 v126, v75
    v_mfma_f32_16x16x32_bf16 v[150:153], v[30:33], v[118:121], v[150:153]
    buffer_load_dwordx4 a[76:79], v6, s[48:51], s94 offen offset:3072 sc1
    s_add_u32 s94, s94, 4096
    v_mfma_f32_16x16x32_bf16 v[154:157], v[34:37], v[106:109], v[154:157]
    ds_read_b64_tr_b16 v[30:31], v17 offset:46592
    v_mov_b32 v130, v76
    v_mfma_f32_16x16x32_bf16 v[158:161], v[34:37], v[110:113], v[158:161]
    ds_read_b64_tr_b16 v[32:33], v17 offset:48384
    v_mov_b32 v134, v77
    v_mfma_f32_16x16x32_bf16 v[162:165], v[34:37], v[114:117], v[162:165]
    v_mov_b32 v123, v78
    v_mov_b32 v127, v79
    v_mfma_f32_16x16x32_bf16 v[166:169], v[34:37], v[118:121], v[166:169]
    buffer_load_dwordx4 a[80:83], v6, s[48:51], s94 offen offset:0 sc1
    v_mfma_f32_16x16x32_bf16 v[170:173], v[38:41], v[106:109], v[170:173]
    ds_read_b64_tr_b16 v[34:35], v17 offset:46624
    v_mov_b32 v131, v80
    v_mfma_f32_16x16x32_bf16 v[174:177], v[38:41], v[110:113], v[174:177]
    ds_read_b64_tr_b16 v[36:37], v17 offset:48416
    v_mov_b32 v135, v81
    v_mfma_f32_16x16x32_bf16 v[178:181], v[38:41], v[114:117], v[178:181]
    v_mov_b32 v124, v82
    v_mov_b32 v128, v83
    v_mfma_f32_16x16x32_bf16 v[182:185], v[38:41], v[118:121], v[182:185]
    buffer_load_dwordx4 a[84:87], v6, s[48:51], s94 offen offset:1024 sc1
    v_mfma_f32_16x16x32_bf16 v[186:189], v[42:45], v[106:109], v[186:189]
    ds_read_b64_tr_b16 v[38:39], v17 offset:46656
    v_mov_b32 v132, v84
    v_mfma_f32_16x16x32_bf16 v[190:193], v[42:45], v[110:113], v[190:193]
    ds_read_b64_tr_b16 v[40:41], v17 offset:48448
    v_mov_b32 v136, v85
    v_mfma_f32_16x16x32_bf16 v[194:197], v[42:45], v[114:117], v[194:197]
    v_mov_b32 v125, v86
    v_mov_b32 v129, v87
    v_mfma_f32_16x16x32_bf16 v[198:201], v[42:45], v[118:121], v[198:201]
    buffer_load_dwordx4 a[88:91], v6, s[48:51], s94 offen offset:2048 sc1
    s_waitcnt lgkmcnt(6)
    v_mfma_f32_16x16x32_bf16 v[202:205], v[46:49], v[106:109], v[202:205]
    ds_read_b64_tr_b16 v[42:43], v20 offset:46592
    v_mov_b32 v133, v88
    v_mfma_f32_16x16x32_bf16 v[206:209], v[46:49], v[110:113], v[206:209]
    ds_read_b64_tr_b16 v[44:45], v20 offset:48384
    v_mov_b32 v137, v89
    v_mfma_f32_16x16x32_bf16 v[210:213], v[46:49], v[114:117], v[210:213]
    v_mfma_f32_16x16x32_bf16 v[214:217], v[46:49], v[118:121], v[214:217]
    buffer_load_dwordx4 a[92:95], v6, s[48:51], s94 offen offset:3072 sc1
    s_add_u32 s94, s94, 4096
    v_mfma_f32_16x16x32_bf16 v[218:221], v[50:53], v[106:109], v[218:221]
    ds_read_b64_tr_b16 v[46:47], v20 offset:46624
    v_mfma_f32_16x16x32_bf16 v[222:225], v[50:53], v[110:113], v[222:225]
    ds_read_b64_tr_b16 v[48:49], v20 offset:48416
    v_mfma_f32_16x16x32_bf16 v[226:229], v[50:53], v[114:117], v[226:229]
    v_mfma_f32_16x16x32_bf16 v[230:233], v[50:53], v[118:121], v[230:233]
    buffer_load_dwordx4 a[96:99], v6, s[48:51], s94 offen offset:0 sc1
    v_mfma_f32_16x16x32_bf16 v[234:237], v[54:57], v[106:109], v[234:237]
    ds_read_b64_tr_b16 v[50:51], v20 offset:46656
    v_mfma_f32_16x16x32_bf16 v[238:241], v[54:57], v[110:113], v[238:241]
    ds_read_b64_tr_b16 v[52:53], v20 offset:48448
    v_mfma_f32_16x16x32_bf16 v[242:245], v[54:57], v[114:117], v[242:245]
    v_mfma_f32_16x16x32_bf16 v[246:249], v[54:57], v[118:121], v[246:249]
    buffer_load_dwordx4 a[100:103], v6, s[48:51], s94 offen offset:1024 sc1
    s_waitcnt lgkmcnt(4)
    v_mfma_f32_16x16x32_bf16 v[138:141], v[30:33], v[122:125], v[138:141]
    ds_read_b64_tr_b16 v[54:55], v21 offset:46592
    ds_read_b128 v[74:77], v12 offset:0
    v_mfma_f32_16x16x32_bf16 v[142:145], v[30:33], v[126:129], v[142:145]
    ds_read_b64_tr_b16 v[56:57], v21 offset:48384
    ds_read_b128 v[78:81], v12 offset:448
    v_mfma_f32_16x16x32_bf16 v[146:149], v[30:33], v[130:133], v[146:149]
    s_waitcnt vmcnt(21)
    v_accvgpr_read_b32 v106, a240
    v_accvgpr_read_b32 v110, a241
    v_mfma_f32_16x16x32_bf16 v[150:153], v[30:33], v[134:137], v[150:153]
    buffer_load_dwordx4 a[104:107], v6, s[48:51], s94 offen offset:2048 sc1
    v_mfma_f32_16x16x32_bf16 v[154:157], v[34:37], v[122:125], v[154:157]
    ds_read_b64_tr_b16 v[30:31], v17 offset:50176
    v_accvgpr_read_b32 v114, a242
    v_mfma_f32_16x16x32_bf16 v[158:161], v[34:37], v[126:129], v[158:161]
    ds_read_b64_tr_b16 v[32:33], v17 offset:51968
    v_accvgpr_read_b32 v118, a243
    v_mfma_f32_16x16x32_bf16 v[162:165], v[34:37], v[130:133], v[162:165]
    v_accvgpr_read_b32 v107, a244
    v_accvgpr_read_b32 v111, a245
    v_mfma_f32_16x16x32_bf16 v[166:169], v[34:37], v[134:137], v[166:169]
    buffer_load_dwordx4 a[108:111], v6, s[48:51], s94 offen offset:3072 sc1
    s_add_u32 s94, s94, 4096
    v_mfma_f32_16x16x32_bf16 v[170:173], v[38:41], v[122:125], v[170:173]
    ds_read_b64_tr_b16 v[34:35], v17 offset:50208
    v_accvgpr_read_b32 v115, a246
    v_mfma_f32_16x16x32_bf16 v[174:177], v[38:41], v[126:129], v[174:177]
    ds_read_b64_tr_b16 v[36:37], v17 offset:52000
    v_accvgpr_read_b32 v119, a247
    v_mfma_f32_16x16x32_bf16 v[178:181], v[38:41], v[130:133], v[178:181]
    v_accvgpr_read_b32 v108, a248
    v_accvgpr_read_b32 v112, a249
    v_mfma_f32_16x16x32_bf16 v[182:185], v[38:41], v[134:137], v[182:185]
    buffer_load_dwordx4 a[112:115], v6, s[48:51], s94 offen offset:0 sc1
    v_mfma_f32_16x16x32_bf16 v[186:189], v[42:45], v[122:125], v[186:189]
    ds_read_b64_tr_b16 v[38:39], v17 offset:50240
    v_accvgpr_read_b32 v116, a250
    v_mfma_f32_16x16x32_bf16 v[190:193], v[42:45], v[126:129], v[190:193]
    ds_read_b64_tr_b16 v[40:41], v17 offset:52032
    v_accvgpr_read_b32 v120, a251
    v_mfma_f32_16x16x32_bf16 v[194:197], v[42:45], v[130:133], v[194:197]
    v_accvgpr_read_b32 v109, a252
    v_accvgpr_read_b32 v113, a253
    v_mfma_f32_16x16x32_bf16 v[198:201], v[42:45], v[134:137], v[198:201]
    buffer_load_dwordx4 a[116:119], v6, s[48:51], s94 offen offset:1024 sc1
    s_waitcnt lgkmcnt(7)
    v_mfma_f32_16x16x32_bf16 v[202:205], v[46:49], v[122:125], v[202:205]
    ds_read_b64_tr_b16 v[42:43], v20 offset:50176
    v_accvgpr_read_b32 v117, a254
    v_mfma_f32_16x16x32_bf16 v[206:209], v[46:49], v[126:129], v[206:209]
    ds_read_b64_tr_b16 v[44:45], v20 offset:51968
    v_accvgpr_read_b32 v121, a255
    v_mfma_f32_16x16x32_bf16 v[210:213], v[46:49], v[130:133], v[210:213]
    ds_read_b128 v[82:85], v12 offset:64
    ds_read_b128 v[86:89], v12 offset:512
    v_mfma_f32_16x16x32_bf16 v[214:217], v[46:49], v[134:137], v[214:217]
    buffer_load_dwordx4 a[120:123], v6, s[48:51], s94 offen offset:2048 sc1
    v_mfma_f32_16x16x32_bf16 v[218:221], v[50:53], v[122:125], v[218:221]
    ds_read_b64_tr_b16 v[46:47], v20 offset:50208
    ds_read_b128 v[58:61], v12 offset:384
    v_mfma_f32_16x16x32_bf16 v[222:225], v[50:53], v[126:129], v[222:225]
    ds_read_b64_tr_b16 v[48:49], v20 offset:52000
    ds_read_b128 v[62:65], v12 offset:832
    v_mfma_f32_16x16x32_bf16 v[226:229], v[50:53], v[130:133], v[226:229]
    v_mfma_f32_16x16x32_bf16 v[230:233], v[50:53], v[134:137], v[230:233]
    buffer_load_dwordx4 a[124:127], v6, s[48:51], s94 offen offset:3072 sc1
    s_add_u32 s94, s94, 4096
    v_mfma_f32_16x16x32_bf16 v[234:237], v[54:57], v[122:125], v[234:237]
    ds_read_b64_tr_b16 v[50:51], v20 offset:50240
    v_mfma_f32_16x16x32_bf16 v[238:241], v[54:57], v[126:129], v[238:241]
    ds_read_b64_tr_b16 v[52:53], v20 offset:52032
    v_mfma_f32_16x16x32_bf16 v[242:245], v[54:57], v[130:133], v[242:245]
    v_mfma_f32_16x16x32_bf16 v[246:249], v[54:57], v[134:137], v[246:249]
    buffer_load_dwordx4 a[128:131], v6, s[48:51], s94 offen offset:0 sc1
    s_waitcnt lgkmcnt(8)
    v_mfma_f32_16x16x32_bf16 v[138:141], v[30:33], v[106:109], v[138:141]
    ds_read_b64_tr_b16 v[54:55], v21 offset:50176
    v_lshlrev_b32 v4, 4, v2
    v_mfma_f32_16x16x32_bf16 v[142:145], v[30:33], v[110:113], v[142:145]
    ds_read_b64_tr_b16 v[56:57], v21 offset:51968
    buffer_load_dwordx4 v[66:69], v4, s[48:51], s81 offen sc1
    v_mfma_f32_16x16x32_bf16 v[146:149], v[30:33], v[114:117], v[146:149]
    s_waitcnt vmcnt(22)
    v_mov_b32 v122, v90
    v_mov_b32 v126, v91
    v_mfma_f32_16x16x32_bf16 v[150:153], v[30:33], v[118:121], v[150:153]
    buffer_load_dwordx4 a[132:135], v6, s[48:51], s94 offen offset:1024 sc1
    v_mfma_f32_16x16x32_bf16 v[154:157], v[34:37], v[106:109], v[154:157]
    ds_read_b64_tr_b16 v[30:31], v17 offset:53760
    v_mov_b32 v130, v92
    v_mfma_f32_16x16x32_bf16 v[158:161], v[34:37], v[110:113], v[158:161]
    ds_read_b64_tr_b16 v[32:33], v17 offset:55552
    v_mov_b32 v134, v93
    v_mfma_f32_16x16x32_bf16 v[162:165], v[34:37], v[114:117], v[162:165]
    v_mov_b32 v123, v94
    v_mov_b32 v127, v95
    v_mfma_f32_16x16x32_bf16 v[166:169], v[34:37], v[118:121], v[166:169]
    buffer_load_dwordx4 a[136:139], v6, s[48:51], s94 offen offset:2048 sc1
    v_mfma_f32_16x16x32_bf16 v[170:173], v[38:41], v[106:109], v[170:173]
    ds_read_b64_tr_b16 v[34:35], v17 offset:53792
    v_mov_b32 v131, v96
    v_mfma_f32_16x16x32_bf16 v[174:177], v[38:41], v[110:113], v[174:177]
    ds_read_b64_tr_b16 v[36:37], v17 offset:55584
    v_mov_b32 v135, v97
    v_mfma_f32_16x16x32_bf16 v[178:181], v[38:41], v[114:117], v[178:181]
    v_mov_b32 v124, v98
    v_mov_b32 v128, v99
    v_mfma_f32_16x16x32_bf16 v[182:185], v[38:41], v[118:121], v[182:185]
    buffer_load_dwordx4 a[140:143], v6, s[48:51], s94 offen offset:3072 sc1
    s_add_u32 s94, s94, 4096
    v_mfma_f32_16x16x32_bf16 v[186:189], v[42:45], v[106:109], v[186:189]
    ds_read_b64_tr_b16 v[38:39], v17 offset:53824
    v_mov_b32 v132, v100
    v_mfma_f32_16x16x32_bf16 v[190:193], v[42:45], v[110:113], v[190:193]
    ds_read_b64_tr_b16 v[40:41], v17 offset:55616
    v_mov_b32 v136, v101
    v_mfma_f32_16x16x32_bf16 v[194:197], v[42:45], v[114:117], v[194:197]
    v_mov_b32 v125, v102
    v_mov_b32 v129, v103
    v_mfma_f32_16x16x32_bf16 v[198:201], v[42:45], v[118:121], v[198:201]
    buffer_load_dwordx4 a[144:147], v6, s[48:51], s94 offen offset:0 sc1
    s_waitcnt lgkmcnt(6)
    v_mfma_f32_16x16x32_bf16 v[202:205], v[46:49], v[106:109], v[202:205]
    ds_read_b64_tr_b16 v[42:43], v20 offset:53760
    v_mov_b32 v133, v104
    v_mfma_f32_16x16x32_bf16 v[206:209], v[46:49], v[110:113], v[206:209]
    ds_read_b64_tr_b16 v[44:45], v20 offset:55552
    v_mov_b32 v137, v105
    v_mfma_f32_16x16x32_bf16 v[210:213], v[46:49], v[114:117], v[210:213]
    v_mfma_f32_16x16x32_bf16 v[214:217], v[46:49], v[118:121], v[214:217]
    buffer_load_dwordx4 a[148:151], v6, s[48:51], s94 offen offset:1024 sc1
    v_mfma_f32_16x16x32_bf16 v[218:221], v[50:53], v[106:109], v[218:221]
    ds_read_b64_tr_b16 v[46:47], v20 offset:53792
    v_mfma_f32_16x16x32_bf16 v[222:225], v[50:53], v[110:113], v[222:225]
    ds_read_b64_tr_b16 v[48:49], v20 offset:55584
    v_mfma_f32_16x16x32_bf16 v[226:229], v[50:53], v[114:117], v[226:229]
    v_mfma_f32_16x16x32_bf16 v[230:233], v[50:53], v[118:121], v[230:233]
    buffer_load_dwordx4 a[152:155], v6, s[48:51], s94 offen offset:2048 sc1
    v_mfma_f32_16x16x32_bf16 v[234:237], v[54:57], v[106:109], v[234:237]
    ds_read_b64_tr_b16 v[50:51], v20 offset:53824
    v_mfma_f32_16x16x32_bf16 v[238:241], v[54:57], v[110:113], v[238:241]
    ds_read_b64_tr_b16 v[52:53], v20 offset:55616
    v_mfma_f32_16x16x32_bf16 v[242:245], v[54:57], v[114:117], v[242:245]
    v_mfma_f32_16x16x32_bf16 v[246:249], v[54:57], v[118:121], v[246:249]
    buffer_load_dwordx4 a[156:159], v6, s[48:51], s94 offen offset:3072 sc1
    s_add_u32 s94, s94, 4096
    s_waitcnt lgkmcnt(4)
    v_mfma_f32_16x16x32_bf16 v[138:141], v[30:33], v[122:125], v[138:141]
    ds_read_b64_tr_b16 v[54:55], v21 offset:53760
    ds_read_b128 v[98:101], v12 offset:192
    v_mfma_f32_16x16x32_bf16 v[142:145], v[30:33], v[126:129], v[142:145]
    ds_read_b64_tr_b16 v[56:57], v21 offset:55552
    ds_read_b128 v[102:105], v12 offset:640
    v_mfma_f32_16x16x32_bf16 v[146:149], v[30:33], v[130:133], v[146:149]
    ds_read_b128 v[106:109], v12 offset:256
    ds_read_b128 v[110:113], v12 offset:704
    v_mfma_f32_16x16x32_bf16 v[150:153], v[30:33], v[134:137], v[150:153]
    buffer_load_dwordx4 a[160:163], v6, s[48:51], s94 offen offset:0 sc1
    v_mfma_f32_16x16x32_bf16 v[154:157], v[34:37], v[122:125], v[154:157]
    ds_read_b128 v[90:93], v12 offset:128
    ds_read_b128 v[94:97], v12 offset:576
    v_mfma_f32_16x16x32_bf16 v[158:161], v[34:37], v[126:129], v[158:161]
    ds_read_b128 v[114:117], v12 offset:320
    ds_read_b128 v[118:121], v12 offset:768
    v_mfma_f32_16x16x32_bf16 v[162:165], v[34:37], v[130:133], v[162:165]
    v_mfma_f32_16x16x32_bf16 v[166:169], v[34:37], v[134:137], v[166:169]
    buffer_load_dwordx4 a[164:167], v6, s[48:51], s94 offen offset:1024 sc1
    v_mfma_f32_16x16x32_bf16 v[170:173], v[38:41], v[122:125], v[170:173]
    v_mfma_f32_16x16x32_bf16 v[174:177], v[38:41], v[126:129], v[174:177]
    v_mfma_f32_16x16x32_bf16 v[178:181], v[38:41], v[130:133], v[178:181]
    v_mfma_f32_16x16x32_bf16 v[182:185], v[38:41], v[134:137], v[182:185]
    buffer_load_dwordx4 a[168:171], v6, s[48:51], s94 offen offset:2048 sc1
    v_mfma_f32_16x16x32_bf16 v[186:189], v[42:45], v[122:125], v[186:189]
    v_mfma_f32_16x16x32_bf16 v[190:193], v[42:45], v[126:129], v[190:193]
    v_mfma_f32_16x16x32_bf16 v[194:197], v[42:45], v[130:133], v[194:197]
    v_mfma_f32_16x16x32_bf16 v[198:201], v[42:45], v[134:137], v[198:201]
    buffer_load_dwordx4 a[172:175], v6, s[48:51], s94 offen offset:3072 sc1
    s_add_u32 s94, s94, 4096
    s_waitcnt lgkmcnt(7)
    v_mfma_f32_16x16x32_bf16 v[202:205], v[46:49], v[122:125], v[202:205]
    v_mfma_f32_16x16x32_bf16 v[206:209], v[46:49], v[126:129], v[206:209]
    s_waitcnt vmcnt(11)
    v_min_u32 v30, v66, v67
    v_min3_u32 v30, v30, v68, v69
    v_mfma_f32_16x16x32_bf16 v[210:213], v[46:49], v[130:133], v[210:213]
    v_cmp_eq_u32 vcc, 0, v30
    s_cbranch_vccnz L_slow9
L_ret11:
    v_mfma_f32_16x16x32_bf16 v[214:217], v[46:49], v[134:137], v[214:217]
    buffer_load_dwordx4 a[176:179], v6, s[48:51], s94 offen offset:0 sc1
    v_mfma_f32_16x16x32_bf16 v[218:221], v[50:53], v[122:125], v[218:221]
    v_lshlrev_b32 v30, 16, v66
    v_and_b32 v32, 0xffff0000, v66
    v_mfma_f32_16x16x32_bf16 v[222:225], v[50:53], v[126:129], v[222:225]
    v_lshlrev_b32 v34, 16, v67
    v_and_b32 v36, 0xffff0000, v67
    v_mfma_f32_16x16x32_bf16 v[226:229], v[50:53], v[130:133], v[226:229]
    v_lshlrev_b32 v38, 16, v68
    v_and_b32 v40, 0xffff0000, v68
    v_mfma_f32_16x16x32_bf16 v[230:233], v[50:53], v[134:137], v[230:233]
    buffer_load_dwordx4 a[180:183], v6, s[48:51], s94 offen offset:1024 sc1
    v_mfma_f32_16x16x32_bf16 v[234:237], v[54:57], v[122:125], v[234:237]
    v_lshlrev_b32 v42, 16, v69
    v_and_b32 v44, 0xffff0000, v69
    v_mfma_f32_16x16x32_bf16 v[238:241], v[54:57], v[126:129], v[238:241]
    v_rcp_f32 v32, v32
    v_mfma_f32_16x16x32_bf16 v[242:245], v[54:57], v[130:133], v[242:245]
    v_rcp_f32 v36, v36
    v_mfma_f32_16x16x32_bf16 v[246:249], v[54:57], v[134:137], v[246:249]
    buffer_load_dwordx4 a[184:187], v6, s[48:51], s94 offen offset:2048 sc1
    v_rcp_f32 v40, v40
    v_rcp_f32 v44, v44
    v_cmp_gt_u32 vcc, 2, v3
    v_mul_f32 v31, 0xbfb8aa3b, v32
    v_mul_f32 v32, 0xbf317218, v32
    v_cndmask_b32 v33, v32, v31, vcc
    v_mul_f32 v35, 0xbfb8aa3b, v36
    v_mul_f32 v36, 0xbf317218, v36
    v_cndmask_b32 v37, v36, v35, vcc
    v_mul_f32 v39, 0xbfb8aa3b, v40
    v_mul_f32 v40, 0xbf317218, v40
    v_cndmask_b32 v41, v40, v39, vcc
    v_mul_f32 v43, 0xbfb8aa3b, v44
    v_mul_f32 v44, 0xbf317218, v44
    v_cndmask_b32 v45, v44, v43, vcc
    v_pk_fma_f32 v[138:139], v[74:75], v[30:31], v[138:139] op_sel:[0,0,0] op_sel_hi:[1,0,1] neg_lo:[0,1,0] neg_hi:[0,1,0]
    v_pk_fma_f32 v[140:141], v[76:77], v[30:31], v[140:141] op_sel:[0,0,0] op_sel_hi:[1,0,1] neg_lo:[0,1,0] neg_hi:[0,1,0]
    v_pk_fma_f32 v[138:139], v[138:139], v[30:31], v[78:79] op_sel:[0,1,0] op_sel_hi:[1,1,1]
    v_pk_fma_f32 v[140:141], v[140:141], v[30:31], v[80:81] op_sel:[0,1,0] op_sel_hi:[1,1,1]
    v_pk_fma_f32 v[186:187], v[98:99], v[30:31], v[186:187] op_sel:[0,0,0] op_sel_hi:[1,0,1] neg_lo:[0,1,0] neg_hi:[0,1,0]
    v_pk_fma_f32 v[188:189], v[100:101], v[30:31], v[188:189] op_sel:[0,0,0] op_sel_hi:[1,0,1] neg_lo:[0,1,0] neg_hi:[0,1,0]
    s_waitcnt lgkmcnt(6)
    v_pk_fma_f32 v[186:187], v[186:187], v[32:33], v[102:103] op_sel:[0,0,0] op_sel_hi:[1,0,1]
    v_pk_fma_f32 v[188:189], v[188:189], v[32:33], v[104:105] op_sel:[0,0,0] op_sel_hi:[1,0,1]
    buffer_load_dwordx4 a[188:191], v6, s[48:51], s94 offen offset:3072 sc1
    s_add_u32 s94, s94, 4096
    v_exp_f32 v50, v138
    v_exp_f32 v51, v139
    v_exp_f32 v52, v140
    v_exp_f32 v53, v141
    v_pk_mul_f32 v[138:139], v[138:139], v[186:187]
    v_pk_mul_f32 v[140:141], v[140:141], v[188:189]
    v_pk_add_f32 v[50:51], v[50:51], v[8:9]
    v_pk_add_f32 v[52:53], v[52:53], v[8:9]
    v_rcp_f32 v50, v50
    v_rcp_f32 v51, v51
    v_rcp_f32 v52, v52
    v_rcp_f32 v53, v53
    v_pk_mul_f32 v[138:139], v[138:139], v[50:51]
    v_pk_mul_f32 v[140:141], v[140:141], v[52:53]
    v_cvt_pk_bf16_f32 v122, v138, v139
    v_cvt_pk_bf16_f32 v123, v140, v141
    v_pk_fma_f32 v[154:155], v[82:83], v[30:31], v[154:155] op_sel:[0,0,0] op_sel_hi:[1,0,1] neg_lo:[0,1,0] neg_hi:[0,1,0]
    v_pk_fma_f32 v[156:157], v[84:85], v[30:31], v[156:157] op_sel:[0,0,0] op_sel_hi:[1,0,1] neg_lo:[0,1,0] neg_hi:[0,1,0]
    v_pk_fma_f32 v[154:155], v[154:155], v[30:31], v[86:87] op_sel:[0,1,0] op_sel_hi:[1,1,1]
    v_pk_fma_f32 v[156:157], v[156:157], v[30:31], v[88:89] op_sel:[0,1,0] op_sel_hi:[1,1,1]
    s_waitcnt lgkmcnt(5)
    v_pk_fma_f32 v[202:203], v[106:107], v[30:31], v[202:203] op_sel:[0,0,0] op_sel_hi:[1,0,1] neg_lo:[0,1,0] neg_hi:[0,1,0]
    v_pk_fma_f32 v[204:205], v[108:109], v[30:31], v[204:205] op_sel:[0,0,0] op_sel_hi:[1,0,1] neg_lo:[0,1,0] neg_hi:[0,1,0]
    s_waitcnt lgkmcnt(4)
    v_pk_fma_f32 v[202:203], v[202:203], v[32:33], v[110:111] op_sel:[0,0,0] op_sel_hi:[1,0,1]
    v_pk_fma_f32 v[204:205], v[204:205], v[32:33], v[112:113] op_sel:[0,0,0] op_sel_hi:[1,0,1]
    buffer_load_dwordx4 a[192:195], v6, s[48:51], s94 offen offset:0 sc1
    v_exp_f32 v50, v154
    v_exp_f32 v51, v155
    v_exp_f32 v52, v156
    v_exp_f32 v53, v157
    v_pk_mul_f32 v[154:155], v[154:155], v[202:203]
    v_pk_mul_f32 v[156:157], v[156:157], v[204:205]
    v_pk_add_f32 v[50:51], v[50:51], v[8:9]
    v_pk_add_f32 v[52:53], v[52:53], v[8:9]
    v_rcp_f32 v50, v50
    v_rcp_f32 v51, v51
    v_rcp_f32 v52, v52
    v_rcp_f32 v53, v53
    v_pk_mul_f32 v[154:155], v[154:155], v[50:51]
    v_pk_mul_f32 v[156:157], v[156:157], v[52:53]
    v_cvt_pk_bf16_f32 v124, v154, v155
    v_cvt_pk_bf16_f32 v125, v156, v157
    buffer_store_dwordx4 v[122:125], v6, s[48:51], s84 offen sc1
    v_pk_fma_f32 v[142:143], v[74:75], v[34:35], v[142:143] op_sel:[0,0,0] op_sel_hi:[1,0,1] neg_lo:[0,1,0] neg_hi:[0,1,0]
    v_pk_fma_f32 v[144:145], v[76:77], v[34:35], v[144:145] op_sel:[0,0,0] op_sel_hi:[1,0,1] neg_lo:[0,1,0] neg_hi:[0,1,0]
    v_pk_fma_f32 v[142:143], v[142:143], v[34:35], v[78:79] op_sel:[0,1,0] op_sel_hi:[1,1,1]
    v_pk_fma_f32 v[144:145], v[144:145], v[34:35], v[80:81] op_sel:[0,1,0] op_sel_hi:[1,1,1]
    v_pk_fma_f32 v[190:191], v[98:99], v[34:35], v[190:191] op_sel:[0,0,0] op_sel_hi:[1,0,1] neg_lo:[0,1,0] neg_hi:[0,1,0]
    v_pk_fma_f32 v[192:193], v[100:101], v[34:35], v[192:193] op_sel:[0,0,0] op_sel_hi:[1,0,1] neg_lo:[0,1,0] neg_hi:[0,1,0]
    v_pk_fma_f32 v[190:191], v[190:191], v[36:37], v[102:103] op_sel:[0,0,0] op_sel_hi:[1,0,1]
    v_pk_fma_f32 v[192:193], v[192:193], v[36:37], v[104:105] op_sel:[0,0,0] op_sel_hi:[1,0,1]
    buffer_load_dwordx4 a[196:199], v6, s[48:51], s94 offen offset:1024 sc1
    v_exp_f32 v50, v142
    v_exp_f32 v51, v143
    v_exp_f32 v52, v144
    v_exp_f32 v53, v145
    v_pk_mul_f32 v[142:143], v[142:143], v[190:191]
    v_pk_mul_f32 v[144:145], v[144:145], v[192:193]
    v_pk_add_f32 v[50:51], v[50:51], v[8:9]
    v_pk_add_f32 v[52:53], v[52:53], v[8:9]
    v_rcp_f32 v50, v50
    v_rcp_f32 v51, v51
    v_rcp_f32 v52, v52
    v_rcp_f32 v53, v53
    v_pk_mul_f32 v[142:143], v[142:143], v[50:51]
    v_pk_mul_f32 v[144:145], v[144:145], v[52:53]
    v_cvt_pk_bf16_f32 v126, v142, v143
    v_cvt_pk_bf16_f32 v127, v144, v145
    v_pk_fma_f32 v[158:159], v[82:83], v[34:35], v[158:159] op_sel:[0,0,0] op_sel_hi:[1,0,1] neg_lo:[0,1,0] neg_hi:[0,1,0]
    v_pk_fma_f32 v[160:161], v[84:85], v[34:35], v[160:161] op_sel:[0,0,0] op_sel_hi:[1,0,1] neg_lo:[0,1,0] neg_hi:[0,1,0]
    v_pk_fma_f32 v[158:159], v[158:159], v[34:35], v[86:87] op_sel:[0,1,0] op_sel_hi:[1,1,1]
    v_pk_fma_f32 v[160:161], v[160:161], v[34:35], v[88:89] op_sel:[0,1,0] op_sel_hi:[1,1,1]
    v_pk_fma_f32 v[206:207], v[106:107], v[34:35], v[206:207] op_sel:[0,0,0] op_sel_hi:[1,0,1] neg_lo:[0,1,0] neg_hi:[0,1,0]
    v_pk_fma_f32 v[208:209], v[108:109], v[34:35], v[208:209] op_sel:[0,0,0] op_sel_hi:[1,0,1] neg_lo:[0,1,0] neg_hi:[0,1,0]
    v_pk_fma_f32 v[206:207], v[206:207], v[36:37], v[110:111] op_sel:[0,0,0] op_sel_hi:[1,0,1]
    v_pk_fma_f32 v[208:209], v[208:209], v[36:37], v[112:113] op_sel:[0,0,0] op_sel_hi:[1,0,1]
    buffer_load_dwordx4 a[200:203], v6, s[48:51], s94 offen offset:2048 sc1
    v_exp_f32 v50, v158
    v_exp_f32 v51, v159
    v_exp_f32 v52, v160
    v_exp_f32 v53, v161
    v_pk_mul_f32 v[158:159], v[158:159], v[206:207]
    v_pk_mul_f32 v[160:161], v[160:161], v[208:209]
    v_pk_add_f32 v[50:51], v[50:51], v[8:9]
    v_pk_add_f32 v[52:53], v[52:53], v[8:9]
    v_rcp_f32 v50, v50
    v_rcp_f32 v51, v51
    v_rcp_f32 v52, v52
    v_rcp_f32 v53, v53
    v_pk_mul_f32 v[158:159], v[158:159], v[50:51]
    v_pk_mul_f32 v[160:161], v[160:161], v[52:53]
    v_cvt_pk_bf16_f32 v128, v158, v159
    v_cvt_pk_bf16_f32 v129, v160, v161
    buffer_store_dwordx4 v[126:129], v6, s[48:51], s80 offen sc1
    v_pk_fma_f32 v[146:147], v[74:75], v[38:39], v[146:147] op_sel:[0,0,0] op_sel_hi:[1,0,1] neg_lo:[0,1,0] neg_hi:[0,1,0]
    v_pk_fma_f32 v[148:149], v[76:77], v[38:39], v[148:149] op_sel:[0,0,0] op_sel_hi:[1,0,1] neg_lo:[0,1,0] neg_hi:[0,1,0]
    v_pk_fma_f32 v[146:147], v[146:147], v[38:39], v[78:79] op_sel:[0,1,0] op_sel_hi:[1,1,1]
    v_pk_fma_f32 v[148:149], v[148:149], v[38:39], v[80:81] op_sel:[0,1,0] op_sel_hi:[1,1,1]
    v_pk_fma_f32 v[194:195], v[98:99], v[38:39], v[194:195] op_sel:[0,0,0] op_sel_hi:[1,0,1] neg_lo:[0,1,0] neg_hi:[0,1,0]
    v_pk_fma_f32 v[196:197], v[100:101], v[38:39], v[196:197] op_sel:[0,0,0] op_sel_hi:[1,0,1] neg_lo:[0,1,0] neg_hi:[0,1,0]
    v_pk_fma_f32 v[194:195], v[194:195], v[40:41], v[102:103] op_sel:[0,0,0] op_sel_hi:[1,0,1]
    v_pk_fma_f32 v[196:197], v[196:197], v[40:41], v[104:105] op_sel:[0,0,0] op_sel_hi:[1,0,1]
    buffer_load_dwordx4 a[204:207], v6, s[48:51], s94 offen offset:3072 sc1
    s_add_u32 s94, s94, 4096
    v_exp_f32 v50, v146
    v_exp_f32 v51, v147
    v_exp_f32 v52, v148
    v_exp_f32 v53, v149
    v_pk_mul_f32 v[146:147], v[146:147], v[194:195]
    v_pk_mul_f32 v[148:149], v[148:149], v[196:197]
    v_pk_add_f32 v[50:51], v[50:51], v[8:9]
    v_pk_add_f32 v[52:53], v[52:53], v[8:9]
    v_rcp_f32 v50, v50
    v_rcp_f32 v51, v51
    v_rcp_f32 v52, v52
    v_rcp_f32 v53, v53
    v_pk_mul_f32 v[146:147], v[146:147], v[50:51]
    v_pk_mul_f32 v[148:149], v[148:149], v[52:53]
    v_cvt_pk_bf16_f32 v122, v146, v147
    v_cvt_pk_bf16_f32 v123, v148, v149
    v_pk_fma_f32 v[162:163], v[82:83], v[38:39], v[162:163] op_sel:[0,0,0] op_sel_hi:[1,0,1] neg_lo:[0,1,0] neg_hi:[0,1,0]
    v_pk_fma_f32 v[164:165], v[84:85], v[38:39], v[164:165] op_sel:[0,0,0] op_sel_hi:[1,0,1] neg_lo:[0,1,0] neg_hi:[0,1,0]
    v_pk_fma_f32 v[162:163], v[162:163], v[38:39], v[86:87] op_sel:[0,1,0] op_sel_hi:[1,1,1]
    v_pk_fma_f32 v[164:165], v[164:165], v[38:39], v[88:89] op_sel:[0,1,0] op_sel_hi:[1,1,1]
    v_pk_fma_f32 v[210:211], v[106:107], v[38:39], v[210:211] op_sel:[0,0,0] op_sel_hi:[1,0,1] neg_lo:[0,1,0] neg_hi:[0,1,0]
    v_pk_fma_f32 v[212:213], v[108:109], v[38:39], v[212:213] op_sel:[0,0,0] op_sel_hi:[1,0,1] neg_lo:[0,1,0] neg_hi:[0,1,0]
    v_pk_fma_f32 v[210:211], v[210:211], v[40:41], v[110:111] op_sel:[0,0,0] op_sel_hi:[1,0,1]
    v_pk_fma_f32 v[212:213], v[212:213], v[40:41], v[112:113] op_sel:[0,0,0] op_sel_hi:[1,0,1]
    v_exp_f32 v50, v162
    v_exp_f32 v51, v163
    v_exp_f32 v52, v164
    v_exp_f32 v53, v165
    v_pk_mul_f32 v[162:163], v[162:163], v[210:211]
    v_pk_mul_f32 v[164:165], v[164:165], v[212:213]
    v_pk_add_f32 v[50:51], v[50:51], v[8:9]
    v_pk_add_f32 v[52:53], v[52:53], v[8:9]
    v_rcp_f32 v50, v50
    v_rcp_f32 v51, v51
    v_rcp_f32 v52, v52
    v_rcp_f32 v53, v53
    v_pk_mul_f32 v[162:163], v[162:163], v[50:51]
    v_pk_mul_f32 v[164:165], v[164:165], v[52:53]
    v_cvt_pk_bf16_f32 v124, v162, v163
    v_cvt_pk_bf16_f32 v125, v164, v165
    buffer_store_dwordx4 v[122:125], v6, s[48:51], s82 offen sc1
    v_pk_fma_f32 v[150:151], v[74:75], v[42:43], v[150:151] op_sel:[0,0,0] op_sel_hi:[1,0,1] neg_lo:[0,1,0] neg_hi:[0,1,0]
    v_pk_fma_f32 v[152:153], v[76:77], v[42:43], v[152:153] op_sel:[0,0,0] op_sel_hi:[1,0,1] neg_lo:[0,1,0] neg_hi:[0,1,0]
    v_pk_fma_f32 v[150:151], v[150:151], v[42:43], v[78:79] op_sel:[0,1,0] op_sel_hi:[1,1,1]
    v_pk_fma_f32 v[152:153], v[152:153], v[42:43], v[80:81] op_sel:[0,1,0] op_sel_hi:[1,1,1]
    v_pk_fma_f32 v[198:199], v[98:99], v[42:43], v[198:199] op_sel:[0,0,0] op_sel_hi:[1,0,1] neg_lo:[0,1,0] neg_hi:[0,1,0]
    v_pk_fma_f32 v[200:201], v[100:101], v[42:43], v[200:201] op_sel:[0,0,0] op_sel_hi:[1,0,1] neg_lo:[0,1,0] neg_hi:[0,1,0]
    v_pk_fma_f32 v[198:199], v[198:199], v[44:45], v[102:103] op_sel:[0,0,0] op_sel_hi:[1,0,1]
    v_pk_fma_f32 v[200:201], v[200:201], v[44:45], v[104:105] op_sel:[0,0,0] op_sel_hi:[1,0,1]
    v_exp_f32 v50, v150
    v_exp_f32 v51, v151
    v_exp_f32 v52, v152
    v_exp_f32 v53, v153
    v_pk_mul_f32 v[150:151], v[150:151], v[198:199]
    v_pk_mul_f32 v[152:153], v[152:153], v[200:201]
    v_pk_add_f32 v[50:51], v[50:51], v[8:9]
    v_pk_add_f32 v[52:53], v[52:53], v[8:9]
    v_rcp_f32 v50, v50
    v_rcp_f32 v51, v51
    v_rcp_f32 v52, v52
    v_rcp_f32 v53, v53
    v_pk_mul_f32 v[150:151], v[150:151], v[50:51]
    v_pk_mul_f32 v[152:153], v[152:153], v[52:53]
    v_cvt_pk_bf16_f32 v126, v150, v151
    v_cvt_pk_bf16_f32 v127, v152, v153
    v_pk_fma_f32 v[166:167], v[82:83], v[42:43], v[166:167] op_sel:[0,0,0] op_sel_hi:[1,0,1] neg_lo:[0,1,0] neg_hi:[0,1,0]
    v_pk_fma_f32 v[168:169], v[84:85], v[42:43], v[168:169] op_sel:[0,0,0] op_sel_hi:[1,0,1] neg_lo:[0,1,0] neg_hi:[0,1,0]
    v_pk_fma_f32 v[166:167], v[166:167], v[42:43], v[86:87] op_sel:[0,1,0] op_sel_hi:[1,1,1]
    v_pk_fma_f32 v[168:169], v[168:169], v[42:43], v[88:89] op_sel:[0,1,0] op_sel_hi:[1,1,1]
    v_pk_fma_f32 v[214:215], v[106:107], v[42:43], v[214:215] op_sel:[0,0,0] op_sel_hi:[1,0,1] neg_lo:[0,1,0] neg_hi:[0,1,0]
    v_pk_fma_f32 v[216:217], v[108:109], v[42:43], v[216:217] op_sel:[0,0,0] op_sel_hi:[1,0,1] neg_lo:[0,1,0] neg_hi:[0,1,0]
    v_pk_fma_f32 v[214:215], v[214:215], v[44:45], v[110:111] op_sel:[0,0,0] op_sel_hi:[1,0,1]
    v_pk_fma_f32 v[216:217], v[216:217], v[44:45], v[112:113] op_sel:[0,0,0] op_sel_hi:[1,0,1]
    v_exp_f32 v50, v166
    v_exp_f32 v51, v167
    v_exp_f32 v52, v168
    v_exp_f32 v53, v169
    v_pk_mul_f32 v[166:167], v[166:167], v[214:215]
    v_pk_mul_f32 v[168:169], v[168:169], v[216:217]
    v_pk_add_f32 v[50:51], v[50:51], v[8:9]
    v_pk_add_f32 v[52:53], v[52:53], v[8:9]
    v_rcp_f32 v50, v50
    v_rcp_f32 v51, v51
    v_rcp_f32 v52, v52
    v_rcp_f32 v53, v53
    v_pk_mul_f32 v[166:167], v[166:167], v[50:51]
    v_pk_mul_f32 v[168:169], v[168:169], v[52:53]
    v_cvt_pk_bf16_f32 v128, v166, v167
    v_cvt_pk_bf16_f32 v129, v168, v169
    buffer_store_dwordx4 v[126:129], v6, s[48:51], s83 offen sc1
    s_waitcnt lgkmcnt(3)
    v_pk_fma_f32 v[170:171], v[90:91], v[30:31], v[170:171] op_sel:[0,0,0] op_sel_hi:[1,0,1] neg_lo:[0,1,0] neg_hi:[0,1,0]
    v_pk_fma_f32 v[172:173], v[92:93], v[30:31], v[172:173] op_sel:[0,0,0] op_sel_hi:[1,0,1] neg_lo:[0,1,0] neg_hi:[0,1,0]
    s_waitcnt lgkmcnt(2)
    v_pk_fma_f32 v[170:171], v[170:171], v[30:31], v[94:95] op_sel:[0,1,0] op_sel_hi:[1,1,1]
    v_pk_fma_f32 v[172:173], v[172:173], v[30:31], v[96:97] op_sel:[0,1,0] op_sel_hi:[1,1,1]
    s_waitcnt lgkmcnt(1)
    v_pk_fma_f32 v[218:219], v[114:115], v[30:31], v[218:219] op_sel:[0,0,0] op_sel_hi:[1,0,1] neg_lo:[0,1,0] neg_hi:[0,1,0]
    v_pk_fma_f32 v[220:221], v[116:117], v[30:31], v[220:221] op_sel:[0,0,0] op_sel_hi:[1,0,1] neg_lo:[0,1,0] neg_hi:[0,1,0]
    s_waitcnt lgkmcnt(0)
    v_pk_fma_f32 v[218:219], v[218:219], v[32:33], v[118:119] op_sel:[0,0,0] op_sel_hi:[1,0,1]
    v_pk_fma_f32 v[220:221], v[220:221], v[32:33], v[120:121] op_sel:[0,0,0] op_sel_hi:[1,0,1]
    v_exp_f32 v50, v170
    v_exp_f32 v51, v171
    v_exp_f32 v52, v172
    v_exp_f32 v53, v173
    v_pk_mul_f32 v[170:171], v[170:171], v[218:219]
    v_pk_mul_f32 v[172:173], v[172:173], v[220:221]
    v_pk_add_f32 v[50:51], v[50:51], v[8:9]
    v_pk_add_f32 v[52:53], v[52:53], v[8:9]
    v_rcp_f32 v50, v50
    v_rcp_f32 v51, v51
    v_rcp_f32 v52, v52
    v_rcp_f32 v53, v53
    v_pk_mul_f32 v[170:171], v[170:171], v[50:51]
    v_pk_mul_f32 v[172:173], v[172:173], v[52:53]
    v_cvt_pk_bf16_f32 v130, v170, v171
    v_cvt_pk_bf16_f32 v131, v172, v173
    v_pk_fma_f32 v[174:175], v[90:91], v[34:35], v[174:175] op_sel:[0,0,0] op_sel_hi:[1,0,1] neg_lo:[0,1,0] neg_hi:[0,1,0]
    v_pk_fma_f32 v[176:177], v[92:93], v[34:35], v[176:177] op_sel:[0,0,0] op_sel_hi:[1,0,1] neg_lo:[0,1,0] neg_hi:[0,1,0]
    v_pk_fma_f32 v[174:175], v[174:175], v[34:35], v[94:95] op_sel:[0,1,0] op_sel_hi:[1,1,1]
    v_pk_fma_f32 v[176:177], v[176:177], v[34:35], v[96:97] op_sel:[0,1,0] op_sel_hi:[1,1,1]
    v_pk_fma_f32 v[222:223], v[114:115], v[34:35], v[222:223] op_sel:[0,0,0] op_sel_hi:[1,0,1] neg_lo:[0,1,0] neg_hi:[0,1,0]
    v_pk_fma_f32 v[224:225], v[116:117], v[34:35], v[224:225] op_sel:[0,0,0] op_sel_hi:[1,0,1] neg_lo:[0,1,0] neg_hi:[0,1,0]
    v_pk_fma_f32 v[222:223], v[222:223], v[36:37], v[118:119] op_sel:[0,0,0] op_sel_hi:[1,0,1]
    v_pk_fma_f32 v[224:225], v[224:225], v[36:37], v[120:121] op_sel:[0,0,0] op_sel_hi:[1,0,1]
    v_exp_f32 v50, v174
    v_exp_f32 v51, v175
    v_exp_f32 v52, v176
    v_exp_f32 v53, v177
    v_pk_mul_f32 v[174:175], v[174:175], v[222:223]
    v_pk_mul_f32 v[176:177], v[176:177], v[224:225]
    v_pk_add_f32 v[50:51], v[50:51], v[8:9]
    v_pk_add_f32 v[52:53], v[52:53], v[8:9]
    v_rcp_f32 v50, v50
    v_rcp_f32 v51, v51
    v_rcp_f32 v52, v52
    v_rcp_f32 v53, v53
    v_pk_mul_f32 v[174:175], v[174:175], v[50:51]
    v_pk_mul_f32 v[176:177], v[176:177], v[52:53]
    v_cvt_pk_bf16_f32 v132, v174, v175
    v_cvt_pk_bf16_f32 v133, v176, v177
    s_nop 0
    v_permlane16_swap_b32 v130, v132
    v_permlane16_swap_b32 v131, v133
    buffer_store_dwordx4 v[130:133], v10, s[48:51], s84 offen offset:1024 sc1
    v_pk_fma_f32 v[178:179], v[90:91], v[38:39], v[178:179] op_sel:[0,0,0] op_sel_hi:[1,0,1] neg_lo:[0,1,0] neg_hi:[0,1,0]
    v_pk_fma_f32 v[180:181], v[92:93], v[38:39], v[180:181] op_sel:[0,0,0] op_sel_hi:[1,0,1] neg_lo:[0,1,0] neg_hi:[0,1,0]
    v_pk_fma_f32 v[178:179], v[178:179], v[38:39], v[94:95] op_sel:[0,1,0] op_sel_hi:[1,1,1]
    v_pk_fma_f32 v[180:181], v[180:181], v[38:39], v[96:97] op_sel:[0,1,0] op_sel_hi:[1,1,1]
    v_pk_fma_f32 v[226:227], v[114:115], v[38:39], v[226:227] op_sel:[0,0,0] op_sel_hi:[1,0,1] neg_lo:[0,1,0] neg_hi:[0,1,0]
    v_pk_fma_f32 v[228:229], v[116:117], v[38:39], v[228:229] op_sel:[0,0,0] op_sel_hi:[1,0,1] neg_lo:[0,1,0] neg_hi:[0,1,0]
    v_pk_fma_f32 v[226:227], v[226:227], v[40:41], v[118:119] op_sel:[0,0,0] op_sel_hi:[1,0,1]
    v_pk_fma_f32 v[228:229], v[228:229], v[40:41], v[120:121] op_sel:[0,0,0] op_sel_hi:[1,0,1]
    v_exp_f32 v50, v178
    v_exp_f32 v51, v179
    v_exp_f32 v52, v180
    v_exp_f32 v53, v181
    v_pk_mul_f32 v[178:179], v[178:179], v[226:227]
    v_pk_mul_f32 v[180:181], v[180:181], v[228:229]
    v_pk_add_f32 v[50:51], v[50:51], v[8:9]
    v_pk_add_f32 v[52:53], v[52:53], v[8:9]
    v_rcp_f32 v50, v50
    v_rcp_f32 v51, v51
    v_rcp_f32 v52, v52
    v_rcp_f32 v53, v53
    v_pk_mul_f32 v[178:179], v[178:179], v[50:51]
    v_pk_mul_f32 v[180:181], v[180:181], v[52:53]
    v_cvt_pk_bf16_f32 v134, v178, v179
    v_cvt_pk_bf16_f32 v135, v180, v181
    v_pk_fma_f32 v[182:183], v[90:91], v[42:43], v[182:183] op_sel:[0,0,0] op_sel_hi:[1,0,1] neg_lo:[0,1,0] neg_hi:[0,1,0]
    v_pk_fma_f32 v[184:185], v[92:93], v[42:43], v[184:185] op_sel:[0,0,0] op_sel_hi:[1,0,1] neg_lo:[0,1,0] neg_hi:[0,1,0]
    v_pk_fma_f32 v[182:183], v[182:183], v[42:43], v[94:95] op_sel:[0,1,0] op_sel_hi:[1,1,1]
    v_pk_fma_f32 v[184:185], v[184:185], v[42:43], v[96:97] op_sel:[0,1,0] op_sel_hi:[1,1,1]
    v_pk_fma_f32 v[230:231], v[114:115], v[42:43], v[230:231] op_sel:[0,0,0] op_sel_hi:[1,0,1] neg_lo:[0,1,0] neg_hi:[0,1,0]
    v_pk_fma_f32 v[232:233], v[116:117], v[42:43], v[232:233] op_sel:[0,0,0] op_sel_hi:[1,0,1] neg_lo:[0,1,0] neg_hi:[0,1,0]
    v_pk_fma_f32 v[230:231], v[230:231], v[44:45], v[118:119] op_sel:[0,0,0] op_sel_hi:[1,0,1]
    v_pk_fma_f32 v[232:233], v[232:233], v[44:45], v[120:121] op_sel:[0,0,0] op_sel_hi:[1,0,1]
    v_exp_f32 v50, v182
    v_exp_f32 v51, v183
    v_exp_f32 v52, v184
    v_exp_f32 v53, v185
    v_pk_mul_f32 v[182:183], v[182:183], v[230:231]
    v_pk_mul_f32 v[184:185], v[184:185], v[232:233]
    v_pk_add_f32 v[50:51], v[50:51], v[8:9]
    v_pk_add_f32 v[52:53], v[52:53], v[8:9]
    v_rcp_f32 v50, v50
    v_rcp_f32 v51, v51
    v_rcp_f32 v52, v52
    v_rcp_f32 v53, v53
    v_pk_mul_f32 v[182:183], v[182:183], v[50:51]
    v_pk_mul_f32 v[184:185], v[184:185], v[52:53]
    v_cvt_pk_bf16_f32 v136, v182, v183
    v_cvt_pk_bf16_f32 v137, v184, v185
    s_nop 0
    v_permlane16_swap_b32 v134, v136
    v_permlane16_swap_b32 v135, v137
    buffer_store_dwordx4 v[134:137], v10, s[48:51], s82 offen offset:1024 sc1
    v_pk_fma_f32 v[234:235], v[58:59], v[30:31], v[234:235] op_sel:[0,0,0] op_sel_hi:[1,0,1] neg_lo:[0,1,0] neg_hi:[0,1,0]
    v_pk_fma_f32 v[236:237], v[60:61], v[30:31], v[236:237] op_sel:[0,0,0] op_sel_hi:[1,0,1] neg_lo:[0,1,0] neg_hi:[0,1,0]
    v_pk_fma_f32 v[234:235], v[234:235], v[32:33], v[62:63] op_sel:[0,1,0] op_sel_hi:[1,1,1]
    v_pk_fma_f32 v[236:237], v[236:237], v[32:33], v[64:65] op_sel:[0,1,0] op_sel_hi:[1,1,1]
    v_pk_fma_f32 v[238:239], v[58:59], v[34:35], v[238:239] op_sel:[0,0,0] op_sel_hi:[1,0,1] neg_lo:[0,1,0] neg_hi:[0,1,0]
    v_pk_fma_f32 v[240:241], v[60:61], v[34:35], v[240:241] op_sel:[0,0,0] op_sel_hi:[1,0,1] neg_lo:[0,1,0] neg_hi:[0,1,0]
    v_pk_fma_f32 v[238:239], v[238:239], v[36:37], v[62:63] op_sel:[0,1,0] op_sel_hi:[1,1,1]
    v_pk_fma_f32 v[240:241], v[240:241], v[36:37], v[64:65] op_sel:[0,1,0] op_sel_hi:[1,1,1]
    v_pk_fma_f32 v[242:243], v[58:59], v[38:39], v[242:243] op_sel:[0,0,0] op_sel_hi:[1,0,1] neg_lo:[0,1,0] neg_hi:[0,1,0]
    v_pk_fma_f32 v[244:245], v[60:61], v[38:39], v[244:245] op_sel:[0,0,0] op_sel_hi:[1,0,1] neg_lo:[0,1,0] neg_hi:[0,1,0]
    v_pk_fma_f32 v[242:243], v[242:243], v[40:41], v[62:63] op_sel:[0,1,0] op_sel_hi:[1,1,1]
    v_pk_fma_f32 v[244:245], v[244:245], v[40:41], v[64:65] op_sel:[0,1,0] op_sel_hi:[1,1,1]
    v_pk_fma_f32 v[246:247], v[58:59], v[42:43], v[246:247] op_sel:[0,0,0] op_sel_hi:[1,0,1] neg_lo:[0,1,0] neg_hi:[0,1,0]
    v_pk_fma_f32 v[248:249], v[60:61], v[42:43], v[248:249] op_sel:[0,0,0] op_sel_hi:[1,0,1] neg_lo:[0,1,0] neg_hi:[0,1,0]
    v_pk_fma_f32 v[246:247], v[246:247], v[44:45], v[62:63] op_sel:[0,1,0] op_sel_hi:[1,1,1]
    v_pk_fma_f32 v[248:249], v[248:249], v[44:45], v[64:65] op_sel:[0,1,0] op_sel_hi:[1,1,1]
    v_permlane32_swap_b32 v234, v238
    v_permlane32_swap_b32 v235, v239
    v_permlane32_swap_b32 v236, v240
    v_permlane32_swap_b32 v237, v241
    v_exp_f32 v50, v234
    v_exp_f32 v51, v235
    v_exp_f32 v52, v236
    v_exp_f32 v53, v237
    v_pk_mul_f32 v[234:235], v[234:235], v[238:239]
    v_pk_mul_f32 v[236:237], v[236:237], v[240:241]
    v_pk_add_f32 v[50:51], v[50:51], v[8:9]
    v_pk_add_f32 v[52:53], v[52:53], v[8:9]
    v_rcp_f32 v50, v50
    v_rcp_f32 v51, v51
    v_rcp_f32 v52, v52
    v_rcp_f32 v53, v53
    v_pk_mul_f32 v[234:235], v[234:235], v[50:51]
    v_pk_mul_f32 v[236:237], v[236:237], v[52:53]
    v_cvt_pk_bf16_f32 v122, v234, v235
    v_cvt_pk_bf16_f32 v123, v236, v237
    v_permlane32_swap_b32 v242, v246
    v_permlane32_swap_b32 v243, v247
    v_permlane32_swap_b32 v244, v248
    v_permlane32_swap_b32 v245, v249
    v_exp_f32 v50, v242
    v_exp_f32 v51, v243
    v_exp_f32 v52, v244
    v_exp_f32 v53, v245
    v_pk_mul_f32 v[242:243], v[242:243], v[246:247]
    v_pk_mul_f32 v[244:245], v[244:245], v[248:249]
    v_pk_add_f32 v[50:51], v[50:51], v[8:9]
    v_pk_add_f32 v[52:53], v[52:53], v[8:9]
    v_rcp_f32 v50, v50
    v_rcp_f32 v51, v51
    v_rcp_f32 v52, v52
    v_rcp_f32 v53, v53
    v_pk_mul_f32 v[242:243], v[242:243], v[50:51]
    v_pk_mul_f32 v[244:245], v[244:245], v[52:53]
    v_cvt_pk_bf16_f32 v124, v242, v243
    v_cvt_pk_bf16_f32 v125, v244, v245
    s_nop 0
    v_permlane16_swap_b32 v122, v124
    v_permlane16_swap_b32 v123, v125
    buffer_store_dwordx4 v[122:125], v11, s[48:51], s84 offen offset:1536 sc1
    s_and_b32 s8, s4, 3
    s_lshr_b32 s9, s3, 0
    s_lshl_b32 s9, s9, 2
    s_add_u32 s8, s8, s9
    s_lshl_b32 s9, s8, 2
    s_add_u32 s10, s9, s5
    s_lshl_b32 s10, s10, 7
    s_add_u32 s89, s10, 19079168
    s_lshl_b32 s8, s8, 6
    s_add_u32 s8, s8, s5
    s_lshr_b32 s10, s4, 2
    s_lshl_b32 s11, s8, 10
    s_lshl_b32 s12, s10, 7
    s_add_u32 s90, s11, s12
    s_add_u32 s91, s12, 19095552
    s_mul_i32 s10, s10, 270336
    s_lshl_b32 s8, s8, 2
    s_add_u32 s8, s8, s10
    s_add_u32 s92, s8, 2359296
    s_mul_i32 s11, s5, 14336
    s_add_u32 s11, s11, 8388608
    v_mov_b32 v8, v6
    v_add_u32 v9, 4096, v6
    v_add_u32 v10, 8192, v6
    v_add_u32 v11, 12288, v6
    v_lshlrev_b32 v15, 12, v2
    v_lshl_add_u32 v15, v3, 4, v15
    v_mul_u32_u24 v19, 33792, v3
    v_lshl_add_u32 v19, v2, 4, v19
    s_lshl_b32 s8, s5, 12
    s_add_u32 s8, s8, 114688
    v_add_u32 v5, s8, v6
    s_add_u32 s8, s5, 1
    s_and_b32 s8, s8, 3
    s_add_u32 s10, s8, s9
    s_mul_i32 s10, s10, 57344
    s_add_u32 s80, s10, s11
    s_lshl_b32 s8, s8, 12
    s_add_u32 s8, s8, 114688
    v_add_u32 v20, s8, v6
    s_add_u32 s8, s5, 2
    s_and_b32 s8, s8, 3
    s_add_u32 s10, s8, s9
    s_mul_i32 s10, s10, 57344
    s_add_u32 s81, s10, s11
    s_lshl_b32 s8, s8, 12
    s_add_u32 s8, s8, 131072
    v_add_u32 v21, s8, v6
    s_add_u32 s8, s5, 3
    s_and_b32 s8, s8, 3
    s_add_u32 s10, s8, s9
    s_mul_i32 s10, s10, 57344
    s_add_u32 s82, s10, s11
    s_lshl_b32 s8, s8, 12
    s_add_u32 s8, s8, 147456
    v_add_u32 v22, s8, v6
    s_add_u32 s8, s5, 4
    s_and_b32 s8, s8, 3
    s_add_u32 s10, s8, s9
    s_mul_i32 s10, s10, 57344
    s_add_u32 s83, s10, s11
    s_add_u32 s8, s92, 0
    buffer_load_dword v24, v19, s[48:51], s8 offen sc1
    s_add_u32 s8, s92, 8448
    buffer_load_dword v25, v19, s[48:51], s8 offen sc1
    s_add_u32 s8, s92, 16896
    buffer_load_dword v26, v19, s[48:51], s8 offen sc1
    s_add_u32 s8, s92, 25344
    buffer_load_dword v27, v19, s[48:51], s8 offen sc1
    s_add_u32 s8, s92, 135168
    buffer_load_dword v28, v19, s[48:51], s8 offen sc1
    s_add_u32 s8, s92, 143616
    buffer_load_dword v29, v19, s[48:51], s8 offen sc1
    s_add_u32 s8, s92, 152064
    buffer_load_dword v30, v19, s[48:51], s8 offen sc1
    s_add_u32 s8, s92, 160512
    buffer_load_dword v31, v19, s[48:51], s8 offen sc1
    v_lshlrev_b32 v4, 4, v3
    buffer_load_dwordx4 v[32:35], v4, s[48:51], s91 offen offset:0 sc1
    buffer_load_dwordx4 v[36:39], v4, s[48:51], s91 offen offset:64 sc1
    v_and_b32 v4, 7, v0
    v_lshlrev_b32 v4, 2, v4
    s_waitcnt vmcnt(10)
    s_lshl_b32 s8, s5, 9
    s_add_u32 s8, s8, s87
    s_mov_b64 exec, 1
    buffer_store_dword v18, off, s[48:51], s8 sc1
    s_mov_b64 exec, -1
    buffer_load_dwordx4 a[208:211], v6, s[48:51], s94 offen offset:0 sc1
    buffer_load_dwordx4 a[212:215], v6, s[48:51], s94 offen offset:1024 sc1
    buffer_load_dwordx4 a[216:219], v6, s[48:51], s94 offen offset:2048 sc1
    buffer_load_dwordx4 a[220:223], v6, s[48:51], s94 offen offset:3072 sc1
    s_add_u32 s94, s94, 4096
    s_waitcnt vmcnt(0)
    s_mov_b32 s6, 32768
L_poll13:
    buffer_load_dword v23, v4, s[48:51], s89 offen offset:0 sc1
    s_waitcnt vmcnt(0)
    v_cmp_ne_u32 vcc, v18, v23
    s_cbranch_vccz L_pend14
    s_sub_u32 s6, s6, 1
    s_cmp_lg_u32 s6, 0
    s_cbranch_scc1 L_poll13
L_pend14:
    buffer_load_dwordx4 v[40:43], v8, s[48:51], s80 offen offset:0 sc1
    buffer_load_dwordx4 v[44:47], v8, s[48:51], s80 offen offset:1024 sc1
    buffer_load_dwordx4 v[48:51], v8, s[48:51], s80 offen offset:2048 sc1
    buffer_load_dwordx4 v[52:55], v8, s[48:51], s80 offen offset:3072 sc1
    buffer_load_dwordx4 v[56:59], v9, s[48:51], s80 offen offset:0 sc1
    buffer_load_dwordx4 v[60:63], v9, s[48:51], s80 offen offset:1024 sc1
    buffer_load_dwordx4 v[64:67], v9, s[48:51], s80 offen offset:2048 sc1
    buffer_load_dwordx4 v[68:71], v9, s[48:51], s80 offen offset:3072 sc1
    buffer_load_dwordx4 v[72:75], v10, s[48:51], s80 offen offset:0 sc1
    buffer_load_dwordx4 v[76:79], v10, s[48:51], s80 offen offset:1024 sc1
    buffer_load_dwordx4 v[80:83], v10, s[48:51], s80 offen offset:2048 sc1
    buffer_load_dwordx4 v[84:87], v10, s[48:51], s80 offen offset:3072 sc1
    v_lshlrev_b32 v120, 16, v24
    v_and_b32 v124, 0xffff0000, v24
    v_lshlrev_b32 v136, 16, v32
    v_and_b32 v140, 0xffff0000, v32
    v_lshlrev_b32 v121, 16, v25
    v_and_b32 v125, 0xffff0000, v25
    v_lshlrev_b32 v137, 16, v33
    v_and_b32 v141, 0xffff0000, v33
    v_lshlrev_b32 v122, 16, v26
    v_and_b32 v126, 0xffff0000, v26
    v_lshlrev_b32 v138, 16, v34
    v_and_b32 v142, 0xffff0000, v34
    v_lshlrev_b32 v123, 16, v27
    v_and_b32 v127, 0xffff0000, v27
    v_lshlrev_b32 v139, 16, v35
    v_and_b32 v143, 0xffff0000, v35
    v_lshlrev_b32 v128, 16, v28
    v_and_b32 v132, 0xffff0000, v28
    v_lshlrev_b32 v144, 16, v36
    v_and_b32 v148, 0xffff0000, v36
    v_lshlrev_b32 v129, 16, v29
    v_and_b32 v133, 0xffff0000, v29
    v_lshlrev_b32 v145, 16, v37
    v_and_b32 v149, 0xffff0000, v37
    v_lshlrev_b32 v130, 16, v30
    v_and_b32 v134, 0xffff0000, v30
    v_lshlrev_b32 v146, 16, v38
    v_and_b32 v150, 0xffff0000, v38
    v_lshlrev_b32 v131, 16, v31
    v_and_b32 v135, 0xffff0000, v31
    v_lshlrev_b32 v147, 16, v39
    v_and_b32 v151, 0xffff0000, v39
    s_waitcnt vmcnt(11)
    v_mfma_f32_16x16x32_bf16 v[88:91], a[0:3], v[40:43], 0
    v_mfma_f32_16x16x32_bf16 v[92:95], a[4:7], v[40:43], 0
    v_mfma_f32_16x16x32_bf16 v[96:99], a[8:11], v[40:43], 0
    v_mfma_f32_16x16x32_bf16 v[100:103], a[12:15], v[40:43], 0
    buffer_load_dwordx4 v[40:43], v11, s[48:51], s80 offen offset:0 sc1
    s_waitcnt vmcnt(11)
    v_mfma_f32_16x16x32_bf16 v[88:91], a[16:19], v[44:47], v[88:91]
    v_mfma_f32_16x16x32_bf16 v[92:95], a[20:23], v[44:47], v[92:95]
    v_mfma_f32_16x16x32_bf16 v[96:99], a[24:27], v[44:47], v[96:99]
    v_mfma_f32_16x16x32_bf16 v[100:103], a[28:31], v[44:47], v[100:103]
    buffer_load_dwordx4 v[44:47], v11, s[48:51], s80 offen offset:1024 sc1
    s_waitcnt vmcnt(11)
    v_mfma_f32_16x16x32_bf16 v[88:91], a[32:35], v[48:51], v[88:91]
    v_mfma_f32_16x16x32_bf16 v[92:95], a[36:39], v[48:51], v[92:95]
    v_mfma_f32_16x16x32_bf16 v[96:99], a[40:43], v[48:51], v[96:99]
    v_mfma_f32_16x16x32_bf16 v[100:103], a[44:47], v[48:51], v[100:103]
    buffer_load_dwordx4 v[48:51], v8, s[48:51], s81 offen offset:0 sc1
    s_waitcnt vmcnt(11)
    v_mfma_f32_16x16x32_bf16 v[88:91], a[48:51], v[52:55], v[88:91]
    v_mfma_f32_16x16x32_bf16 v[92:95], a[52:55], v[52:55], v[92:95]
    v_mfma_f32_16x16x32_bf16 v[96:99], a[56:59], v[52:55], v[96:99]
    v_mfma_f32_16x16x32_bf16 v[100:103], a[60:63], v[52:55], v[100:103]
    buffer_load_dwordx4 v[52:55], v8, s[48:51], s81 offen offset:1024 sc1
    s_waitcnt vmcnt(11)
    v_mfma_f32_16x16x32_bf16 v[88:91], a[64:67], v[56:59], v[88:91]
    v_mfma_f32_16x16x32_bf16 v[92:95], a[68:71], v[56:59], v[92:95]
    v_mfma_f32_16x16x32_bf16 v[96:99], a[72:75], v[56:59], v[96:99]
    v_mfma_f32_16x16x32_bf16 v[100:103], a[76:79], v[56:59], v[100:103]
    buffer_load_dwordx4 v[56:59], v8, s[48:51], s81 offen offset:2048 sc1
    s_waitcnt vmcnt(11)
    v_mfma_f32_16x16x32_bf16 v[88:91], a[80:83], v[60:63], v[88:91]
    v_mfma_f32_16x16x32_bf16 v[92:95], a[84:87], v[60:63], v[92:95]
    v_mfma_f32_16x16x32_bf16 v[96:99], a[88:91], v[60:63], v[96:99]
    v_mfma_f32_16x16x32_bf16 v[100:103], a[92:95], v[60:63], v[100:103]
    buffer_load_dwordx4 v[60:63], v8, s[48:51], s81 offen offset:3072 sc1
    s_waitcnt vmcnt(11)
    v_mfma_f32_16x16x32_bf16 v[88:91], a[96:99], v[64:67], v[88:91]
    v_mfma_f32_16x16x32_bf16 v[92:95], a[100:103], v[64:67], v[92:95]
    v_mfma_f32_16x16x32_bf16 v[96:99], a[104:107], v[64:67], v[96:99]
    v_mfma_f32_16x16x32_bf16 v[100:103], a[108:111], v[64:67], v[100:103]
    buffer_load_dwordx4 v[64:67], v9, s[48:51], s81 offen offset:0 sc1
    s_waitcnt vmcnt(11)
    v_mfma_f32_16x16x32_bf16 v[88:91], a[112:115], v[68:71], v[88:91]
    v_mfma_f32_16x16x32_bf16 v[92:95], a[116:119], v[68:71], v[92:95]
    v_mfma_f32_16x16x32_bf16 v[96:99], a[120:123], v[68:71], v[96:99]
    v_mfma_f32_16x16x32_bf16 v[100:103], a[124:127], v[68:71], v[100:103]
    buffer_load_dwordx4 v[68:71], v9, s[48:51], s81 offen offset:1024 sc1
    s_waitcnt vmcnt(11)
    v_mfma_f32_16x16x32_bf16 v[88:91], a[128:131], v[72:75], v[88:91]
    v_mfma_f32_16x16x32_bf16 v[92:95], a[132:135], v[72:75], v[92:95]
    v_mfma_f32_16x16x32_bf16 v[96:99], a[136:139], v[72:75], v[96:99]
    v_mfma_f32_16x16x32_bf16 v[100:103], a[140:143], v[72:75], v[100:103]
    buffer_load_dwordx4 v[72:75], v9, s[48:51], s81 offen offset:2048 sc1
    s_waitcnt vmcnt(11)
    v_mfma_f32_16x16x32_bf16 v[88:91], a[144:147], v[76:79], v[88:91]
    v_mfma_f32_16x16x32_bf16 v[92:95], a[148:151], v[76:79], v[92:95]
    v_mfma_f32_16x16x32_bf16 v[96:99], a[152:155], v[76:79], v[96:99]
    v_mfma_f32_16x16x32_bf16 v[100:103], a[156:159], v[76:79], v[100:103]
    buffer_load_dwordx4 v[76:79], v9, s[48:51], s81 offen offset:3072 sc1
    s_waitcnt vmcnt(11)
    v_mfma_f32_16x16x32_bf16 v[88:91], a[160:163], v[80:83], v[88:91]
    v_mfma_f32_16x16x32_bf16 v[92:95], a[164:167], v[80:83], v[92:95]
    v_mfma_f32_16x16x32_bf16 v[96:99], a[168:171], v[80:83], v[96:99]
    v_mfma_f32_16x16x32_bf16 v[100:103], a[172:175], v[80:83], v[100:103]
    buffer_load_dwordx4 v[80:83], v10, s[48:51], s81 offen offset:0 sc1
    s_waitcnt vmcnt(11)
    v_mfma_f32_16x16x32_bf16 v[88:91], a[176:179], v[84:87], v[88:91]
    v_mfma_f32_16x16x32_bf16 v[92:95], a[180:183], v[84:87], v[92:95]
    v_mfma_f32_16x16x32_bf16 v[96:99], a[184:187], v[84:87], v[96:99]
    v_mfma_f32_16x16x32_bf16 v[100:103], a[188:191], v[84:87], v[100:103]
    buffer_load_dwordx4 v[84:87], v10, s[48:51], s81 offen offset:1024 sc1
    s_waitcnt vmcnt(11)
    v_mfma_f32_16x16x32_bf16 v[88:91], a[192:195], v[40:43], v[88:91]
    v_mfma_f32_16x16x32_bf16 v[92:95], a[196:199], v[40:43], v[92:95]
    v_mfma_f32_16x16x32_bf16 v[96:99], a[200:203], v[40:43], v[96:99]
    v_mfma_f32_16x16x32_bf16 v[100:103], a[204:207], v[40:43], v[100:103]
    buffer_load_dwordx4 v[40:43], v10, s[48:51], s81 offen offset:2048 sc1
    s_waitcnt vmcnt(11)
    v_mfma_f32_16x16x32_bf16 v[88:91], a[208:211], v[44:47], v[88:91]
    v_mfma_f32_16x16x32_bf16 v[92:95], a[212:215], v[44:47], v[92:95]
    v_mfma_f32_16x16x32_bf16 v[96:99], a[216:219], v[44:47], v[96:99]
    v_mfma_f32_16x16x32_bf16 v[100:103], a[220:223], v[44:47], v[100:103]
    buffer_load_dwordx4 v[44:47], v10, s[48:51], s81 offen offset:3072 sc1
    s_waitcnt vmcnt(11)
    v_mfma_f32_16x16x32_bf16 v[104:107], a[0:3], v[48:51], 0
    v_mfma_f32_16x16x32_bf16 v[108:111], a[4:7], v[48:51], 0
    v_mfma_f32_16x16x32_bf16 v[112:115], a[8:11], v[48:51], 0
    v_mfma_f32_16x16x32_bf16 v[116:119], a[12:15], v[48:51], 0
    buffer_load_dwordx4 v[48:51], v11, s[48:51], s81 offen offset:0 sc1
    s_waitcnt vmcnt(11)
    v_mfma_f32_16x16x32_bf16 v[104:107], a[16:19], v[52:55], v[104:107]
    v_mfma_f32_16x16x32_bf16 v[108:111], a[20:23], v[52:55], v[108:111]
    v_mfma_f32_16x16x32_bf16 v[112:115], a[24:27], v[52:55], v[112:115]
    v_mfma_f32_16x16x32_bf16 v[116:119], a[28:31], v[52:55], v[116:119]
    buffer_load_dwordx4 v[52:55], v11, s[48:51], s81 offen offset:1024 sc1
    s_waitcnt vmcnt(11)
    v_mfma_f32_16x16x32_bf16 v[104:107], a[32:35], v[56:59], v[104:107]
    ds_write_b128 v20, v[88:91] offset:0
    v_mfma_f32_16x16x32_bf16 v[108:111], a[36:39], v[56:59], v[108:111]
    ds_write_b128 v20, v[92:95] offset:1024
    v_mfma_f32_16x16x32_bf16 v[112:115], a[40:43], v[56:59], v[112:115]
    ds_write_b128 v20, v[96:99] offset:2048
    v_mfma_f32_16x16x32_bf16 v[116:119], a[44:47], v[56:59], v[116:119]
    ds_write_b128 v20, v[100:103] offset:3072
    buffer_load_dwordx4 v[56:59], v8, s[48:51], s82 offen offset:0 sc1
    s_waitcnt vmcnt(11)
    v_mfma_f32_16x16x32_bf16 v[104:107], a[48:51], v[60:63], v[104:107]
    v_mfma_f32_16x16x32_bf16 v[108:111], a[52:55], v[60:63], v[108:111]
    v_mfma_f32_16x16x32_bf16 v[112:115], a[56:59], v[60:63], v[112:115]
    v_mfma_f32_16x16x32_bf16 v[116:119], a[60:63], v[60:63], v[116:119]
    buffer_load_dwordx4 v[60:63], v8, s[48:51], s82 offen offset:1024 sc1
    s_waitcnt vmcnt(11)
    v_mfma_f32_16x16x32_bf16 v[104:107], a[64:67], v[64:67], v[104:107]
    v_mfma_f32_16x16x32_bf16 v[108:111], a[68:71], v[64:67], v[108:111]
    v_mfma_f32_16x16x32_bf16 v[112:115], a[72:75], v[64:67], v[112:115]
    v_mfma_f32_16x16x32_bf16 v[116:119], a[76:79], v[64:67], v[116:119]
    buffer_load_dwordx4 v[64:67], v8, s[48:51], s82 offen offset:2048 sc1
    s_waitcnt vmcnt(11)
    v_mfma_f32_16x16x32_bf16 v[104:107], a[80:83], v[68:71], v[104:107]
    v_mfma_f32_16x16x32_bf16 v[108:111], a[84:87], v[68:71], v[108:111]
    v_mfma_f32_16x16x32_bf16 v[112:115], a[88:91], v[68:71], v[112:115]
    v_mfma_f32_16x16x32_bf16 v[116:119], a[92:95], v[68:71], v[116:119]
    buffer_load_dwordx4 v[68:71], v8, s[48:51], s82 offen offset:3072 sc1
    s_waitcnt vmcnt(11)
    v_mfma_f32_16x16x32_bf16 v[104:107], a[96:99], v[72:75], v[104:107]
    v_mfma_f32_16x16x32_bf16 v[108:111], a[100:103], v[72:75], v[108:111]
    v_mfma_f32_16x16x32_bf16 v[112:115], a[104:107], v[72:75], v[112:115]
    v_mfma_f32_16x16x32_bf16 v[116:119], a[108:111], v[72:75], v[116:119]
    buffer_load_dwordx4 v[72:75], v9, s[48:51], s82 offen offset:0 sc1
    s_waitcnt vmcnt(11)
    v_mfma_f32_16x16x32_bf16 v[104:107], a[112:115], v[76:79], v[104:107]
    v_mfma_f32_16x16x32_bf16 v[108:111], a[116:119], v[76:79], v[108:111]
    v_mfma_f32_16x16x32_bf16 v[112:115], a[120:123], v[76:79], v[112:115]
    v_mfma_f32_16x16x32_bf16 v[116:119], a[124:127], v[76:79], v[116:119]
    buffer_load_dwordx4 v[76:79], v9, s[48:51], s82 offen offset:1024 sc1
    s_waitcnt vmcnt(11)
    v_mfma_f32_16x16x32_bf16 v[104:107], a[128:131], v[80:83], v[104:107]
    v_mfma_f32_16x16x32_bf16 v[108:111], a[132:135], v[80:83], v[108:111]
    v_mfma_f32_16x16x32_bf16 v[112:115], a[136:139], v[80:83], v[112:115]
    v_mfma_f32_16x16x32_bf16 v[116:119], a[140:143], v[80:83], v[116:119]
    buffer_load_dwordx4 v[80:83], v9, s[48:51], s82 offen offset:2048 sc1
    s_waitcnt vmcnt(11)
    v_mfma_f32_16x16x32_bf16 v[104:107], a[144:147], v[84:87], v[104:107]
    v_mfma_f32_16x16x32_bf16 v[108:111], a[148:151], v[84:87], v[108:111]
    v_mfma_f32_16x16x32_bf16 v[112:115], a[152:155], v[84:87], v[112:115]
    v_mfma_f32_16x16x32_bf16 v[116:119], a[156:159], v[84:87], v[116:119]
    buffer_load_dwordx4 v[84:87], v9, s[48:51], s82 offen offset:3072 sc1
    s_waitcnt vmcnt(11)
    v_mfma_f32_16x16x32_bf16 v[104:107], a[160:163], v[40:43], v[104:107]
    v_mfma_f32_16x16x32_bf16 v[108:111], a[164:167], v[40:43], v[108:111]
    v_mfma_f32_16x16x32_bf16 v[112:115], a[168:171], v[40:43], v[112:115]
    v_mfma_f32_16x16x32_bf16 v[116:119], a[172:175], v[40:43], v[116:119]
    buffer_load_dwordx4 v[40:43], v10, s[48:51], s82 offen offset:0 sc1
    s_waitcnt vmcnt(11)
    v_mfma_f32_16x16x32_bf16 v[104:107], a[176:179], v[44:47], v[104:107]
    v_mfma_f32_16x16x32_bf16 v[108:111], a[180:183], v[44:47], v[108:111]
    v_mfma_f32_16x16x32_bf16 v[112:115], a[184:187], v[44:47], v[112:115]
    v_mfma_f32_16x16x32_bf16 v[116:119], a[188:191], v[44:47], v[116:119]
    buffer_load_dwordx4 v[44:47], v10, s[48:51], s82 offen offset:1024 sc1
    s_waitcnt vmcnt(11)
    v_mfma_f32_16x16x32_bf16 v[104:107], a[192:195], v[48:51], v[104:107]
    v_mfma_f32_16x16x32_bf16 v[108:111], a[196:199], v[48:51], v[108:111]
    v_mfma_f32_16x16x32_bf16 v[112:115], a[200:203], v[48:51], v[112:115]
    v_mfma_f32_16x16x32_bf16 v[116:119], a[204:207], v[48:51], v[116:119]
    buffer_load_dwordx4 v[48:51], v10, s[48:51], s82 offen offset:2048 sc1
    s_waitcnt vmcnt(11)
    v_mfma_f32_16x16x32_bf16 v[104:107], a[208:211], v[52:55], v[104:107]
    v_mfma_f32_16x16x32_bf16 v[108:111], a[212:215], v[52:55], v[108:111]
    v_mfma_f32_16x16x32_bf16 v[112:115], a[216:219], v[52:55], v[112:115]
    v_mfma_f32_16x16x32_bf16 v[116:119], a[220:223], v[52:55], v[116:119]
    buffer_load_dwordx4 v[52:55], v10, s[48:51], s82 offen offset:3072 sc1
    s_waitcnt vmcnt(11)
    v_mfma_f32_16x16x32_bf16 v[88:91], a[0:3], v[56:59], 0
    v_mfma_f32_16x16x32_bf16 v[92:95], a[4:7], v[56:59], 0
    v_mfma_f32_16x16x32_bf16 v[96:99], a[8:11], v[56:59], 0
    v_mfma_f32_16x16x32_bf16 v[100:103], a[12:15], v[56:59], 0
    buffer_load_dwordx4 v[56:59], v11, s[48:51], s82 offen offset:0 sc1
    s_waitcnt vmcnt(11)
    v_mfma_f32_16x16x32_bf16 v[88:91], a[16:19], v[60:63], v[88:91]
    v_mfma_f32_16x16x32_bf16 v[92:95], a[20:23], v[60:63], v[92:95]
    v_mfma_f32_16x16x32_bf16 v[96:99], a[24:27], v[60:63], v[96:99]
    v_mfma_f32_16x16x32_bf16 v[100:103], a[28:31], v[60:63], v[100:103]
    buffer_load_dwordx4 v[60:63], v11, s[48:51], s82 offen offset:1024 sc1
    s_waitcnt vmcnt(11)
    v_mfma_f32_16x16x32_bf16 v[88:91], a[32:35], v[64:67], v[88:91]
    ds_write_b128 v21, v[104:107] offset:0
    v_mfma_f32_16x16x32_bf16 v[92:95], a[36:39], v[64:67], v[92:95]
    ds_write_b128 v21, v[108:111] offset:1024
    v_mfma_f32_16x16x32_bf16 v[96:99], a[40:43], v[64:67], v[96:99]
    ds_write_b128 v21, v[112:115] offset:2048
    v_mfma_f32_16x16x32_bf16 v[100:103], a[44:47], v[64:67], v[100:103]
    ds_write_b128 v21, v[116:119] offset:3072
    buffer_load_dwordx4 v[64:67], v8, s[48:51], s83 offen offset:0 sc1
    s_waitcnt vmcnt(11)
    v_mfma_f32_16x16x32_bf16 v[88:91], a[48:51], v[68:71], v[88:91]
    v_mfma_f32_16x16x32_bf16 v[92:95], a[52:55], v[68:71], v[92:95]
    v_mfma_f32_16x16x32_bf16 v[96:99], a[56:59], v[68:71], v[96:99]
    v_mfma_f32_16x16x32_bf16 v[100:103], a[60:63], v[68:71], v[100:103]
    buffer_load_dwordx4 v[68:71], v8, s[48:51], s83 offen offset:1024 sc1
    s_waitcnt vmcnt(11)
    v_mfma_f32_16x16x32_bf16 v[88:91], a[64:67], v[72:75], v[88:91]
    v_mfma_f32_16x16x32_bf16 v[92:95], a[68:71], v[72:75], v[92:95]
    v_mfma_f32_16x16x32_bf16 v[96:99], a[72:75], v[72:75], v[96:99]
    v_mfma_f32_16x16x32_bf16 v[100:103], a[76:79], v[72:75], v[100:103]
    buffer_load_dwordx4 v[72:75], v8, s[48:51], s83 offen offset:2048 sc1
    s_waitcnt vmcnt(11)
    v_mfma_f32_16x16x32_bf16 v[88:91], a[80:83], v[76:79], v[88:91]
    v_mfma_f32_16x16x32_bf16 v[92:95], a[84:87], v[76:79], v[92:95]
    v_mfma_f32_16x16x32_bf16 v[96:99], a[88:91], v[76:79], v[96:99]
    v_mfma_f32_16x16x32_bf16 v[100:103], a[92:95], v[76:79], v[100:103]
    buffer_load_dwordx4 v[76:79], v8, s[48:51], s83 offen offset:3072 sc1
    s_waitcnt vmcnt(11)
    v_mfma_f32_16x16x32_bf16 v[88:91], a[96:99], v[80:83], v[88:91]
    v_mfma_f32_16x16x32_bf16 v[92:95], a[100:103], v[80:83], v[92:95]
    v_mfma_f32_16x16x32_bf16 v[96:99], a[104:107], v[80:83], v[96:99]
    v_mfma_f32_16x16x32_bf16 v[100:103], a[108:111], v[80:83], v[100:103]
    buffer_load_dwordx4 v[80:83], v9, s[48:51], s83 offen offset:0 sc1
    s_waitcnt vmcnt(11)
    v_mfma_f32_16x16x32_bf16 v[88:91], a[112:115], v[84:87], v[88:91]
    v_mfma_f32_16x16x32_bf16 v[92:95], a[116:119], v[84:87], v[92:95]
    v_mfma_f32_16x16x32_bf16 v[96:99], a[120:123], v[84:87], v[96:99]
    v_mfma_f32_16x16x32_bf16 v[100:103], a[124:127], v[84:87], v[100:103]
    buffer_load_dwordx4 v[84:87], v9, s[48:51], s83 offen offset:1024 sc1
    s_waitcnt vmcnt(11)
    v_mfma_f32_16x16x32_bf16 v[88:91], a[128:131], v[40:43], v[88:91]
    v_mfma_f32_16x16x32_bf16 v[92:95], a[132:135], v[40:43], v[92:95]
    v_mfma_f32_16x16x32_bf16 v[96:99], a[136:139], v[40:43], v[96:99]
    v_mfma_f32_16x16x32_bf16 v[100:103], a[140:143], v[40:43], v[100:103]
    buffer_load_dwordx4 v[40:43], v9, s[48:51], s83 offen offset:2048 sc1
    s_waitcnt vmcnt(11)
    v_mfma_f32_16x16x32_bf16 v[88:91], a[144:147], v[44:47], v[88:91]
    v_mfma_f32_16x16x32_bf16 v[92:95], a[148:151], v[44:47], v[92:95]
    v_mfma_f32_16x16x32_bf16 v[96:99], a[152:155], v[44:47], v[96:99]
    v_mfma_f32_16x16x32_bf16 v[100:103], a[156:159], v[44:47], v[100:103]
    buffer_load_dwordx4 v[44:47], v9, s[48:51], s83 offen offset:3072 sc1
    s_waitcnt vmcnt(11)
    v_mfma_f32_16x16x32_bf16 v[88:91], a[160:163], v[48:51], v[88:91]
    v_mfma_f32_16x16x32_bf16 v[92:95], a[164:167], v[48:51], v[92:95]
    v_mfma_f32_16x16x32_bf16 v[96:99], a[168:171], v[48:51], v[96:99]
    v_mfma_f32_16x16x32_bf16 v[100:103], a[172:175], v[48:51], v[100:103]
    buffer_load_dwordx4 v[48:51], v10, s[48:51], s83 offen offset:0 sc1
    s_waitcnt vmcnt(11)
    v_mfma_f32_16x16x32_bf16 v[88:91], a[176:179], v[52:55], v[88:91]
    v_mfma_f32_16x16x32_bf16 v[92:95], a[180:183], v[52:55], v[92:95]
    v_mfma_f32_16x16x32_bf16 v[96:99], a[184:187], v[52:55], v[96:99]
    v_mfma_f32_16x16x32_bf16 v[100:103], a[188:191], v[52:55], v[100:103]
    buffer_load_dwordx4 v[52:55], v10, s[48:51], s83 offen offset:1024 sc1
    s_waitcnt vmcnt(11)
    v_mfma_f32_16x16x32_bf16 v[88:91], a[192:195], v[56:59], v[88:91]
    v_mfma_f32_16x16x32_bf16 v[92:95], a[196:199], v[56:59], v[92:95]
    v_mfma_f32_16x16x32_bf16 v[96:99], a[200:203], v[56:59], v[96:99]
    v_mfma_f32_16x16x32_bf16 v[100:103], a[204:207], v[56:59], v[100:103]
    buffer_load_dwordx4 v[56:59], v10, s[48:51], s83 offen offset:2048 sc1
    s_waitcnt vmcnt(11)
    v_mfma_f32_16x16x32_bf16 v[88:91], a[208:211], v[60:63], v[88:91]
    v_mfma_f32_16x16x32_bf16 v[92:95], a[212:215], v[60:63], v[92:95]
    v_mfma_f32_16x16x32_bf16 v[96:99], a[216:219], v[60:63], v[96:99]
    v_mfma_f32_16x16x32_bf16 v[100:103], a[220:223], v[60:63], v[100:103]
    buffer_load_dwordx4 v[60:63], v10, s[48:51], s83 offen offset:3072 sc1
    s_waitcnt vmcnt(11)
    v_mfma_f32_16x16x32_bf16 v[104:107], a[0:3], v[64:67], 0
    v_mfma_f32_16x16x32_bf16 v[108:111], a[4:7], v[64:67], 0
    v_mfma_f32_16x16x32_bf16 v[112:115], a[8:11], v[64:67], 0
    v_mfma_f32_16x16x32_bf16 v[116:119], a[12:15], v[64:67], 0
    buffer_load_dwordx4 v[64:67], v11, s[48:51], s83 offen offset:0 sc1
    s_waitcnt vmcnt(11)
    v_mfma_f32_16x16x32_bf16 v[104:107], a[16:19], v[68:71], v[104:107]
    v_mfma_f32_16x16x32_bf16 v[108:111], a[20:23], v[68:71], v[108:111]
    v_mfma_f32_16x16x32_bf16 v[112:115], a[24:27], v[68:71], v[112:115]
    v_mfma_f32_16x16x32_bf16 v[116:119], a[28:31], v[68:71], v[116:119]
    buffer_load_dwordx4 v[68:71], v11, s[48:51], s83 offen offset:1024 sc1
    s_or_b32 s8, s2, s5
    s_cmp_eq_u32 s8, 0
    s_mov_b32 s8, 1073741824
    s_cselect_b32 s8, 18939904, s8
    s_mov_b64 exec, 1
    buffer_store_dword v18, off, s[48:51], s8 sc1
    s_mov_b64 exec, -1
    s_waitcnt vmcnt(12)
    v_mfma_f32_16x16x32_bf16 v[104:107], a[32:35], v[72:75], v[104:107]
    ds_write_b128 v22, v[88:91] offset:0
    v_mfma_f32_16x16x32_bf16 v[108:111], a[36:39], v[72:75], v[108:111]
    ds_write_b128 v22, v[92:95] offset:1024
    v_mfma_f32_16x16x32_bf16 v[112:115], a[40:43], v[72:75], v[112:115]
    ds_write_b128 v22, v[96:99] offset:2048
    v_mfma_f32_16x16x32_bf16 v[116:119], a[44:47], v[72:75], v[116:119]
    ds_write_b128 v22, v[100:103] offset:3072
    s_waitcnt vmcnt(11)
    v_mfma_f32_16x16x32_bf16 v[104:107], a[48:51], v[76:79], v[104:107]
    v_mfma_f32_16x16x32_bf16 v[108:111], a[52:55], v[76:79], v[108:111]
    v_mfma_f32_16x16x32_bf16 v[112:115], a[56:59], v[76:79], v[112:115]
    v_mfma_f32_16x16x32_bf16 v[116:119], a[60:63], v[76:79], v[116:119]
    s_waitcnt vmcnt(10)
    v_mfma_f32_16x16x32_bf16 v[104:107], a[64:67], v[80:83], v[104:107]
    v_mfma_f32_16x16x32_bf16 v[108:111], a[68:71], v[80:83], v[108:111]
    v_mfma_f32_16x16x32_bf16 v[112:115], a[72:75], v[80:83], v[112:115]
    v_mfma_f32_16x16x32_bf16 v[116:119], a[76:79], v[80:83], v[116:119]
    s_waitcnt lgkmcnt(0)
    s_barrier
    s_waitcnt vmcnt(9)
    v_mfma_f32_16x16x32_bf16 v[104:107], a[80:83], v[84:87], v[104:107]
    ds_read_b128 v[152:155], v5 offset:0
    v_mfma_f32_16x16x32_bf16 v[108:111], a[84:87], v[84:87], v[108:111]
    ds_read_b128 v[156:159], v5 offset:1024
    v_mfma_f32_16x16x32_bf16 v[112:115], a[88:91], v[84:87], v[112:115]
    ds_read_b128 v[160:163], v5 offset:2048
    v_mfma_f32_16x16x32_bf16 v[116:119], a[92:95], v[84:87], v[116:119]
    ds_read_b128 v[164:167], v5 offset:3072
    s_waitcnt vmcnt(8)
    v_mfma_f32_16x16x32_bf16 v[104:107], a[96:99], v[40:43], v[104:107]
    ds_read_b128 v[88:91], v5 offset:16384
    v_mfma_f32_16x16x32_bf16 v[108:111], a[100:103], v[40:43], v[108:111]
    ds_read_b128 v[92:95], v5 offset:17408
    v_mfma_f32_16x16x32_bf16 v[112:115], a[104:107], v[40:43], v[112:115]
    ds_read_b128 v[96:99], v5 offset:18432
    v_mfma_f32_16x16x32_bf16 v[116:119], a[108:111], v[40:43], v[116:119]
    ds_read_b128 v[100:103], v5 offset:19456
    s_waitcnt vmcnt(7)
    v_mfma_f32_16x16x32_bf16 v[104:107], a[112:115], v[44:47], v[104:107]
    s_waitcnt lgkmcnt(3)
    v_add_f32 v152, v152, v88
    v_add_f32 v153, v153, v89
    v_mfma_f32_16x16x32_bf16 v[108:111], a[116:119], v[44:47], v[108:111]
    v_add_f32 v154, v154, v90
    v_add_f32 v155, v155, v91
    v_mfma_f32_16x16x32_bf16 v[112:115], a[120:123], v[44:47], v[112:115]
    s_waitcnt lgkmcnt(2)
    v_add_f32 v156, v156, v92
    v_add_f32 v157, v157, v93
    v_mfma_f32_16x16x32_bf16 v[116:119], a[124:127], v[44:47], v[116:119]
    v_add_f32 v158, v158, v94
    v_add_f32 v159, v159, v95
    s_waitcnt vmcnt(6)
    v_mfma_f32_16x16x32_bf16 v[104:107], a[128:131], v[48:51], v[104:107]
    s_waitcnt lgkmcnt(1)
    v_add_f32 v160, v160, v96
    v_add_f32 v161, v161, v97
    v_mfma_f32_16x16x32_bf16 v[108:111], a[132:135], v[48:51], v[108:111]
    v_add_f32 v162, v162, v98
    v_add_f32 v163, v163, v99
    v_mfma_f32_16x16x32_bf16 v[112:115], a[136:139], v[48:51], v[112:115]
    s_waitcnt lgkmcnt(0)
    v_add_f32 v164, v164, v100
    v_add_f32 v165, v165, v101
    v_mfma_f32_16x16x32_bf16 v[116:119], a[140:143], v[48:51], v[116:119]
    v_add_f32 v166, v166, v102
    v_add_f32 v167, v167, v103
    s_waitcnt vmcnt(5)
    v_mfma_f32_16x16x32_bf16 v[104:107], a[144:147], v[52:55], v[104:107]
    ds_read_b128 v[88:91], v5 offset:32768
    v_mfma_f32_16x16x32_bf16 v[108:111], a[148:151], v[52:55], v[108:111]
    ds_read_b128 v[92:95], v5 offset:33792
    v_mfma_f32_16x16x32_bf16 v[112:115], a[152:155], v[52:55], v[112:115]
    ds_read_b128 v[96:99], v5 offset:34816
    v_mfma_f32_16x16x32_bf16 v[116:119], a[156:159], v[52:55], v[116:119]
    ds_read_b128 v[100:103], v5 offset:35840
    s_waitcnt vmcnt(4)
    v_mfma_f32_16x16x32_bf16 v[104:107], a[160:163], v[56:59], v[104:107]
    s_waitcnt lgkmcnt(3)
    v_add_f32 v152, v152, v88
    v_add_f32 v153, v153, v89
    v_mfma_f32_16x16x32_bf16 v[108:111], a[164:167], v[56:59], v[108:111]
    v_add_f32 v154, v154, v90
    v_add_f32 v155, v155, v91
    v_mfma_f32_16x16x32_bf16 v[112:115], a[168:171], v[56:59], v[112:115]
    s_waitcnt lgkmcnt(2)
    v_add_f32 v156, v156, v92
    v_add_f32 v157, v157, v93
    v_mfma_f32_16x16x32_bf16 v[116:119], a[172:175], v[56:59], v[116:119]
    v_add_f32 v158, v158, v94
    v_add_f32 v159, v159, v95
    s_waitcnt vmcnt(3)
    v_mfma_f32_16x16x32_bf16 v[104:107], a[176:179], v[60:63], v[104:107]
    s_waitcnt lgkmcnt(1)
    v_add_f32 v160, v160, v96
    v_add_f32 v161, v161, v97
    v_mfma_f32_16x16x32_bf16 v[108:111], a[180:183], v[60:63], v[108:111]
    v_add_f32 v162, v162, v98
    v_add_f32 v163, v163, v99
    v_mfma_f32_16x16x32_bf16 v[112:115], a[184:187], v[60:63], v[112:115]
    s_waitcnt lgkmcnt(0)
    v_add_f32 v164, v164, v100
    v_add_f32 v165, v165, v101
    v_mfma_f32_16x16x32_bf16 v[116:119], a[188:191], v[60:63], v[116:119]
    v_add_f32 v166, v166, v102
    v_add_f32 v167, v167, v103
    s_waitcnt vmcnt(2)
    v_mfma_f32_16x16x32_bf16 v[104:107], a[192:195], v[64:67], v[104:107]
    v_fmac_f32 v120, v152, v136
    v_fmac_f32 v121, v153, v137
    v_mfma_f32_16x16x32_bf16 v[108:111], a[196:199], v[64:67], v[108:111]
    v_fmac_f32 v122, v154, v138
    v_fmac_f32 v123, v155, v139
    v_mfma_f32_16x16x32_bf16 v[112:115], a[200:203], v[64:67], v[112:115]
    v_fmac_f32 v124, v156, v140
    v_fmac_f32 v125, v157, v141
    v_mfma_f32_16x16x32_bf16 v[116:119], a[204:207], v[64:67], v[116:119]
    v_fmac_f32 v126, v158, v142
    v_fmac_f32 v127, v159, v143
    s_waitcnt vmcnt(1)
    v_mfma_f32_16x16x32_bf16 v[104:107], a[208:211], v[68:71], v[104:107]
    v_fmac_f32 v128, v160, v144
    v_fmac_f32 v129, v161, v145
    v_mfma_f32_16x16x32_bf16 v[108:111], a[212:215], v[68:71], v[108:111]
    v_fmac_f32 v130, v162, v146
    v_fmac_f32 v131, v163, v147
    v_mfma_f32_16x16x32_bf16 v[112:115], a[216:219], v[68:71], v[112:115]
    v_fmac_f32 v132, v164, v148
    v_fmac_f32 v133, v165, v149
    v_mfma_f32_16x16x32_bf16 v[116:119], a[220:223], v[68:71], v[116:119]
    v_fmac_f32 v134, v166, v150
    v_fmac_f32 v135, v167, v151
    v_pk_fma_f32 v[120:121], v[104:105], v[136:137], v[120:121]
    v_pk_fma_f32 v[122:123], v[106:107], v[138:139], v[122:123]
    v_pk_fma_f32 v[124:125], v[108:109], v[140:141], v[124:125]
    v_pk_fma_f32 v[126:127], v[110:111], v[142:143], v[126:127]
    v_cvt_pk_bf16_f32 v152, v120, v124
    v_cvt_pk_bf16_f32 v153, v121, v125
    v_cvt_pk_bf16_f32 v154, v122, v126
    v_cvt_pk_bf16_f32 v155, v123, v127
    buffer_store_dwordx4 v[152:155], v15, s[60:63], s90 offen offset:0
    v_pk_fma_f32 v[128:129], v[112:113], v[144:145], v[128:129]
    v_pk_fma_f32 v[130:131], v[114:115], v[146:147], v[130:131]
    v_pk_fma_f32 v[132:133], v[116:117], v[148:149], v[132:133]
    v_pk_fma_f32 v[134:135], v[118:119], v[150:151], v[134:135]
    v_cvt_pk_bf16_f32 v156, v128, v132
    v_cvt_pk_bf16_f32 v157, v129, v133
    v_cvt_pk_bf16_f32 v158, v130, v134
    v_cvt_pk_bf16_f32 v159, v131, v135
    buffer_store_dwordx4 v[156:159], v15, s[60:63], s90 offen offset:64
    s_waitcnt vmcnt(0)
L_end:
s_endpgm
L_slow5:
    s_nop 7
    s_nop 7
    s_mov_b32 s6, 32768
L_sl6:
    buffer_load_dword v58, v16, s[48:51], 0 offen sc1
    s_waitcnt vmcnt(0)
    v_cmp_ne_u32 vcc, v18, v58
    s_cbranch_vccz L_sx8
    s_sub_u32 s6, s6, 1
    s_cmp_lg_u32 s6, 0
    s_cbranch_scc1 L_sl6
L_sx8:
    s_nop 1
    s_branch L_ret7
L_slow9:
    s_nop 7
    s_nop 7
    s_mov_b32 s6, 32768
L_sl10:
    buffer_load_dwordx4 v[66:69], v4, s[48:51], s81 offen sc1
    s_waitcnt vmcnt(0)
    v_min_u32 v30, v66, v67
    v_min3_u32 v30, v30, v68, v69
    v_cmp_eq_u32 vcc, 0, v30
    s_cbranch_vccz L_sx12
    s_sub_u32 s6, s6, 1
    s_cmp_lg_u32 s6, 0
    s_cbranch_scc1 L_sl10
L_sx12:
    s_nop 1
    s_branch L_ret11
L_code_end:
.section .rodata,"a"
.p2align 6
.amdhsa_kernel adaLN_cond__ssm_conv_s4d__swiglu_ffn__prompt_kernel
  .amdhsa_next_free_vgpr 512
  .amdhsa_next_free_sgpr 102
  .amdhsa_accum_offset 256
  .amdhsa_group_segment_fixed_size 0
  .amdhsa_kernarg_size 128
  .amdhsa_user_sgpr_count 2
  .amdhsa_user_sgpr_kernarg_segment_ptr 1
  .amdhsa_system_sgpr_workgroup_id_x 1
  .amdhsa_float_denorm_mode_32 3
  .amdhsa_float_denorm_mode_16_64 3
.end_amdhsa_kernel
```
